```python
import torch

def _softmax(x, axis=-1):
    return torch.softmax(x, dim=axis)
def _gelu(x):
    return torch.nn.functional.gelu(x, approximate="tanh")
def _silu(x):
    return torch.nn.functional.silu(x)
def _sigmoid(x):
    return torch.sigmoid(x)
def _layernorm(x, axis=-1, eps=1e-5):
    m = x.mean(dim=axis, keepdim=True)
    v = x.var(dim=axis, keepdim=True, unbiased=False)
    return (x - m) / torch.sqrt(v + eps)
def _scatter_add(tgt, idx, src, axis=0):
    return tgt.clone().index_add_(axis, idx, src)
def _segment_sum(src, seg, n):
    out = torch.zeros((n,) + src.shape[1:], dtype=src.dtype)
    return out.index_add_(0, seg, src)
def _pad(x, pw):
    flat = tuple(v for pair in reversed(pw) for v in pair)
    return torch.nn.functional.pad(x, flat)

kernel_name = 'concat_heads__grouped_kv_mqa__ssm_conv_s4__prompt'

def setup_inputs():

    _w = (lambda a: (lambda t: t.to(torch.bfloat16) if t.is_floating_point() else t)(torch.as_tensor(a)))
    def _A_setup():
        B, S, D, H = 1, 2048, 512, 32
        Dh = D // H
        return {
            "x": _w((lambda *s: torch.randn(*s, dtype=torch.bfloat16) * 0.05)(B, S, D)),
            "wq": _w((lambda *s: torch.randn(*s, dtype=torch.bfloat16) * 0.8)(D, H * Dh)),
            "wk": _w((lambda *s: torch.randn(*s, dtype=torch.bfloat16) * 0.8)(D, Dh)),
            "wv": _w((lambda *s: torch.randn(*s, dtype=torch.bfloat16) * 0.05)(D, Dh)),
            "wo": _w((lambda *s: torch.randn(*s, dtype=torch.bfloat16) * 0.05)(H * Dh, D)),
        }
    _A_in = _A_setup()

    def _B_setup():
        B, L, D, N = 1, 2048, 512, 128
        A_re = -(lambda _x: torch.exp(torch.as_tensor(_x)))((lambda *s: torch.randn(*s, dtype=torch.bfloat16) * 3.2)(D, N))
        A_im = torch.pi * (lambda *s: torch.randn(*s, dtype=torch.bfloat16) * 0.05)(D, N)
        B_re = (lambda *s: torch.randn(*s, dtype=torch.bfloat16) * 0.1)(D, N)
        B_im = (lambda *s: torch.randn(*s, dtype=torch.bfloat16) * 0.1)(D, N)
        C_re = (lambda *s: torch.randn(*s, dtype=torch.bfloat16) * 0.1)(D, N)
        C_im = (lambda *s: torch.randn(*s, dtype=torch.bfloat16) * 0.1)(D, N)
        log_dt = (lambda *s: torch.randn(*s, dtype=torch.bfloat16) * 0.05)(D) * 0.5 - 4.0
        Dskip = (lambda *s: torch.randn(*s, dtype=torch.bfloat16) * 0.05)(D)
        return {
            "u": _w((lambda *s: torch.randn(*s, dtype=torch.bfloat16) * 0.05)(B, L, D)),
            "A_re": _w(A_re),
            "A_im": _w(A_im),
            "B_re": _w(B_re),
            "B_im": _w(B_im),
            "C_re": _w(C_re),
            "C_im": _w(C_im),
            "log_dt": _w(log_dt),
            "Dskip": _w(Dskip),
        }
    _B_in = _B_setup()

    return {
        "A_x": _A_in["x"],
        "A_wq": _A_in["wq"],
        "A_wk": _A_in["wk"],
        "A_wv": _A_in["wv"],
        "A_wo": _A_in["wo"],
        "B_u": _B_in["u"],
        "B_A_re": _B_in["A_re"],
        "B_A_im": _B_in["A_im"],
        "B_B_re": _B_in["B_re"],
        "B_B_im": _B_in["B_im"],
        "B_C_re": _B_in["C_re"],
        "B_C_im": _B_in["C_im"],
        "B_log_dt": _B_in["log_dt"],
        "B_Dskip": _B_in["Dskip"],
    }

def reference(A_x, A_wq, A_wk, A_wv, A_wo, B_u, B_A_re, B_A_im, B_B_re, B_B_im, B_C_re, B_C_im, B_log_dt, B_Dskip):
    def _A_ref(x, wq, wk, wv, wo):
        B, S, D = x.shape
        H = 32
        Dh = D // H
        q = (lambda x, *d: x.permute(*d))((x @ wq).reshape(B, S, H, Dh), 0, 2, 1, 3)
        k = x @ wk
        v = x @ wv
        scores = torch.einsum("bhqd,bkd->bhqk", q, k) * (Dh ** -0.5)
        p = _softmax(scores, axis=-1)
        o = torch.einsum("bhqk,bkd->bhqd", p, v)
        return (lambda x, *d: x.permute(*d))(o, 0, 2, 1, 3).reshape(B, S, H * Dh) @ wo

    def _B_ref(u, A_re, A_im, B_re, B_im, C_re, C_im, log_dt, Dskip):
        Bsz, L, D = u.shape
        dt = torch.exp(log_dt)[:, None]
        A = A_re + 1j * A_im
        Bc = B_re + 1j * B_im
        Cc = C_re + 1j * C_im
        logdA = dt * A
        dB = dt * Bc
        l = (lambda x, dt: x.to(dt))(torch.arange(L), A_re.dtype)
        P = torch.exp(logdA[:, :, None] * l[None, None, :])
        K = torch.einsum("dn,dnl,dn->dl", Cc, P, dB).real
        L2 = 2 * L
        Kp = _pad(K, ((0, 0), (0, L)))
        up = (lambda x, *d: x.permute(*d))(u, 0, 2, 1)
        up = _pad(up, ((0, 0), (0, 0), (0, L)))
        Kf = (lambda x, axes=(-2,-1): torch.fft.rfft2(x.float(), dim=axes))(Kp[:, None, :], axes=(-2, -1))
        Uf = (lambda x, axes=(-2,-1): torch.fft.rfft2(x.float(), dim=axes))(up[:, :, None, :], axes=(-2, -1))
        Yf = Uf * Kf[None, :, :, :]
        y = (lambda x, s, axes=(-2,-1): torch.fft.irfft2(x, s=s, dim=axes).to(torch.bfloat16))(Yf, (1, L2), axes=(-2, -1))[:, :, 0, :L]
        y = (lambda x, *d: x.permute(*d))(y, 0, 2, 1) + u * Dskip[None, None, :]
        return y

    a = _A_ref(A_x, A_wq, A_wk, A_wv, A_wo)
    b = _B_ref(B_u, B_A_re, B_A_im, B_B_re, B_B_im, B_C_re, B_C_im, B_log_dt, B_Dskip)
    return torch.concatenate([a, b], axis=-1)
```

```asm
; @launch grid=(256,1,1) block=(768,1,1) lds=160000
.amdgcn_target "amdgcn-amd-amdhsa--gfx950"
.text
.globl concat_heads__grouped_kv_mqa__ssm_conv_s4__prompt_kernel
.p2align 8
.type concat_heads__grouped_kv_mqa__ssm_conv_s4__prompt_kernel,@function
concat_heads__grouped_kv_mqa__ssm_conv_s4__prompt_kernel:
    s_cmp_ge_u32 s2, 256
    s_cbranch_scc1 L_exit
    s_load_dwordx16 s[16:31], s[0:1], 0
    s_load_dwordx16 s[32:47], s[0:1], 64
    s_load_dwordx2 s[48:49], s[0:1], 128
    v_lshrrev_b32 v3, 6, v0
    v_and_b32 v0, 63, v0
    v_readfirstlane_b32 s3, v3
    v_mov_b32 v1, 159744
    v_mov_b32 v2, 1
    s_and_b32 s8, s2, 7
    s_lshr_b32 s9, s2, 3
    s_lshl_b32 s4, s8, 2
    s_lshr_b32 s10, s9, 3
    s_add_u32 s4, s4, s10
    s_and_b32 s5, s9, 7
    s_lshl_b32 s6, s8, 5
    s_add_u32 s6, s6, s9
    s_and_b32 s15, s9, 15
    s_mov_b32 s51, 200000
    s_and_b32 s7, s3, 3
    s_lshr_b32 s14, s3, 2
    s_lshl_b32 s14, s14, 2
    s_lshr_b32 s14, 513, s14
    s_and_b32 s14, s14, 3
    s_mov_b32 s66, 16777216
    s_mov_b32 s67, 0x20000
    s_mov_b32 s55, 0x20000
    s_mov_b32 s59, 0x20000
    s_cmp_eq_u32 s14, 2
    s_cbranch_scc1 L_role_s
    s_mov_b32 s54, 2097152
    s_cmp_eq_u32 s14, 0
    s_cbranch_scc1 L_role_early
    s_setprio 3
    s_and_b32 s8, s5, 3
    s_lshl_b32 s9, s4, 2
    s_add_u32 s9, s9, s8
    s_lshl_b32 s9, s9, 14
    s_lshl_b32 s10, s7, 8
    s_add_u32 s9, s9, s10
    v_and_b32 v4, 15, v0
    v_lshrrev_b32 v5, 4, v0
    v_lshlrev_b32 v6, 10, v4
    v_lshl_add_u32 v6, v5, 4, v6
    s_lshl_b32 s10, s7, 12
    v_lshrrev_b32 v7, 4, v0
    v_and_b32 v7, 1, v7
    v_lshlrev_b32 v7, 7, v7
    v_lshlrev_b32 v24, 4, v0
    v_xor_b32 v7, v7, v24
    s_add_u32 m0, s10, 0
    s_mov_b32 s58, 16384
    s_waitcnt lgkmcnt(0)
    s_mov_b32 s64, s48
    s_mov_b32 s65, s49
    s_mov_b32 s52, s16
    s_mov_b32 s53, s17
    s_load_dword s50, s[48:49], 0
    buffer_load_dwordx4 v[8:11], v6, s[52:55], s9 offen offset:0
    buffer_load_dwordx4 v[12:15], v6, s[52:55], s9 offen offset:64
    buffer_load_dwordx4 v[16:19], v6, s[52:55], s9 offen offset:128
    buffer_load_dwordx4 v[20:23], v6, s[52:55], s9 offen offset:192
    s_cmp_ge_u32 s5, 4
    s_cselect_b32 s56, s22, s20
    s_cselect_b32 s57, s23, s21
    buffer_load_dwordx4 v7, s[56:59], s10 offen offset:0 lds
    buffer_load_dwordx4 v7, s[56:59], s10 offen offset:1024 lds
    buffer_load_dwordx4 v7, s[56:59], s10 offen offset:2048 lds
    buffer_load_dwordx4 v7, s[56:59], s10 offen offset:3072 lds
    v_bfe_u32 v25, v0, 2, 2
    v_lshl_add_u32 v25, v5, 3, v25
    v_and_b32 v26, 1, v5
    v_lshl_add_u32 v25, v26, 2, v25
    v_lshlrev_b32 v25, 5, v25
    v_and_b32 v26, 3, v0
    v_lshl_add_u32 v25, v26, 3, v25
    v_add_u32 v25, s10, v25
    v_xor_b32 v26, 0x80, v25
    s_mov_b32 s41, 0
    v_xor_b32 v6, v4, v5
    v_lshlrev_b32 v6, 4, v6
    v_lshl_add_u32 v6, v4, 10, v6
    v_add_u32 v152, 32768, v6
    v_xor_b32 v153, 64, v152
    v_xor_b32 v154, 0x80, v152
    v_xor_b32 v155, 0xc0, v152
    v_bfe_u32 v6, v0, 2, 2
    v_lshl_add_u32 v7, v5, 3, v6
    v_lshlrev_b32 v7, 7, v7
    v_and_b32 v6, 2, v6
    v_and_b32 v72, 1, v5
    v_lshl_add_u32 v6, v72, 2, v6
    s_lshl_b32 s9, s7, 1
    v_xor_b32 v6, s9, v6
    v_lshl_add_u32 v7, v6, 4, v7
    v_and_b32 v6, 3, v0
    v_lshl_add_u32 v7, v6, 3, v7
    v_add_u32 v156, 65536, v7
    v_lshrrev_b32 v6, 1, v5
    v_lshlrev_b32 v6, 9, v6
    v_lshl_add_u32 v6, v4, 4, v6
    v_lshl_add_u32 v6, v72, 3, v6
    s_lshl_b32 s9, s7, 10
    s_add_u32 s9, s9, 147456
    v_add_u32 v157, s9, v6
    s_and_b32 s9, s5, 1
    s_lshl_b32 s9, s9, 14
    s_lshl_b32 s11, s7, 8
    s_add_u32 s9, s9, s11
    v_add_u32 v64, s9, v152
    v_add_u32 v65, s9, v153
    v_add_u32 v66, s9, v154
    v_add_u32 v67, s9, v155
    s_mul_i32 s10, s7, 45056
    s_add_u32 s10, s10, 147456
    v_and_b32 v72, 31, v0
    v_lshrrev_b32 v73, 5, v0
    v_lshlrev_b32 v158, 5, v72
    v_lshl_add_u32 v158, v73, 4, v158
    v_and_b32 v74, 3, v72
    v_bfe_u32 v75, v72, 2, 1
    v_lshl_add_u32 v74, v75, 3, v74
    v_bfe_u32 v75, v72, 3, 1
    v_lshl_add_u32 v74, v75, 2, v74
    v_lshlrev_b32 v74, 5, v74
    s_mov_b32 s12, 0xffff
    s_mov_b32 s13, 0xffff
    v_mov_b32 v75, 2146435072
    v_cndmask_b32 v74, v75, v74, s[12:13]
    s_mov_b32 s12, 0x110000
    s_mov_b32 s13, 0x110000
    v_mov_b32 v75, 512
    v_cndmask_b32 v74, v74, v75, s[12:13]
    v_lshl_add_u32 v159, v73, 4, v74
    v_add_u32 v158, s10, v158
    v_add_u32 v159, s10, v159
    s_add_u32 s10, s7, 0
    s_and_b32 s10, s10, 3
    s_mul_i32 s28, s10, 6912
    s_add_u32 s10, s7, 1
    s_and_b32 s10, s10, 3
    s_mul_i32 s29, s10, 6912
    s_add_u32 s10, s7, 2
    s_and_b32 s10, s10, 3
    s_mul_i32 s30, s10, 6912
    s_add_u32 s10, s7, 3
    s_and_b32 s10, s10, 3
    s_mul_i32 s31, s10, 6912
    s_cmp_eq_u32 s14, 0
    s_cselect_b32 s10, 32768, 0
    s_add_u32 s28, s28, s10
    s_add_u32 s29, s29, s10
    s_add_u32 s30, s30, s10
    s_add_u32 s31, s31, s10
    s_lshl_b32 s11, s4, 1
    s_add_u32 s11, s11, s14
    s_lshl_b32 s11, s11, 5
    s_lshl_b32 s12, s5, 2
    s_add_u32 s11, s11, s12
    s_add_u32 s11, s11, s7
    s_lshl_b32 s11, s11, 10
    s_add_u32 s32, s11, 524288
    s_cmp_eq_u32 s14, 0
    s_mov_b32 s33, 19
    s_cselect_b32 s34, 11, 13
    s_lshl_b32 s33, s33, 2
    s_lshl_b32 s34, s34, 2
    s_add_u32 s33, s33, 159744
    s_add_u32 s34, s34, 159744
    s_cmp_eq_u32 s14, 0
    s_cselect_b32 s35, 4, 7
    s_lshl_b32 s35, 1, s35
    s_lshl_b32 s10, s14, 12
    s_add_u32 s10, s10, 147456
    v_lshl_add_u32 v72, v0, 4, s10
    s_add_u32 s11, s7, 0
    s_and_b32 s11, s11, 3
    s_lshl_b32 s11, s11, 10
    v_add_u32 v160, s11, v72
    s_add_u32 s11, s7, 1
    s_and_b32 s11, s11, 3
    s_lshl_b32 s11, s11, 10
    v_add_u32 v161, s11, v72
    s_add_u32 s11, s7, 2
    s_and_b32 s11, s11, 3
    s_lshl_b32 s11, s11, 10
    v_add_u32 v162, s11, v72
    s_add_u32 s11, s7, 3
    s_and_b32 s11, s11, 3
    s_lshl_b32 s11, s11, 10
    v_add_u32 v163, s11, v72
    s_mul_i32 s36, s15, 2816
    s_add_u32 s15, s15, 1
    s_and_b32 s15, s15, 15
    s_mul_i32 s37, s15, 2816
    s_add_u32 s15, s15, 1
    s_and_b32 s15, s15, 15
    s_mul_i32 s38, s15, 2816
    s_add_u32 s15, s15, 1
    s_and_b32 s15, s15, 15
    s_mul_i32 s39, s15, 2816
    s_mov_b32 s69, 2146435072
    s_waitcnt vmcnt(0) lgkmcnt(0)
    ds_read_b64_tr_b16 v[32:33], v25 offset:0
    ds_read_b64_tr_b16 v[34:35], v26 offset:0
    ds_read_b64_tr_b16 v[36:37], v25 offset:1024
    ds_read_b64_tr_b16 v[38:39], v26 offset:1024
    ds_read_b64_tr_b16 v[40:41], v25 offset:2048
    ds_read_b64_tr_b16 v[42:43], v26 offset:2048
    ds_read_b64_tr_b16 v[44:45], v25 offset:3072
    ds_read_b64_tr_b16 v[46:47], v26 offset:3072
    s_cmp_ge_u32 s5, 4
    s_cbranch_scc1 L_kv_v
    s_waitcnt lgkmcnt(6)
    v_mfma_f32_16x16x32_bf16 v[48:51], v[32:35], v[8:11], 0
    s_waitcnt lgkmcnt(4)
    v_mfma_f32_16x16x32_bf16 v[48:51], v[36:39], v[12:15], v[48:51]
    s_waitcnt lgkmcnt(2)
    v_mfma_f32_16x16x32_bf16 v[48:51], v[40:43], v[16:19], v[48:51]
    s_waitcnt lgkmcnt(0)
    v_mfma_f32_16x16x32_bf16 v[48:51], v[44:47], v[20:23], v[48:51]
    s_branch L_kv_j
L_kv_v:
    s_waitcnt lgkmcnt(6)
    v_mfma_f32_16x16x32_bf16 v[48:51], v[8:11], v[32:35], 0
    s_waitcnt lgkmcnt(4)
    v_mfma_f32_16x16x32_bf16 v[48:51], v[12:15], v[36:39], v[48:51]
    s_waitcnt lgkmcnt(2)
    v_mfma_f32_16x16x32_bf16 v[48:51], v[16:19], v[40:43], v[48:51]
    s_waitcnt lgkmcnt(0)
    v_mfma_f32_16x16x32_bf16 v[48:51], v[20:23], v[44:47], v[48:51]
L_kv_j:
    s_barrier
    s_lshl_b32 s10, s7, 10
    s_add_u32 s10, s10, 155648
    v_add_u32 v27, s10, v24
    s_add_u32 s11, s50, 0x9e3779b9
    v_mov_b32 v28, s11
    ds_write_b32 v1, v28 offset:128
    s_nop 3
    ds_write_b128 v27, v[48:51]
    s_waitcnt lgkmcnt(0)
    s_mov_b64 exec, 1
    ds_add_rtn_u32 v3, v1, v2 offset:0
    s_mov_b64 exec, -1
    s_waitcnt lgkmcnt(0)
    v_readfirstlane_b32 s8, v3
    s_nop 2
    s_cmp_eq_u32 s8, 3
    s_cbranch_scc0 L_kv_done
    v_add_u32 v27, 155648, v24
    ds_read_b128 v[48:51], v27
    ds_read_b128 v[52:55], v27 offset:1024
    ds_read_b128 v[56:59], v27 offset:2048
    ds_read_b128 v[60:63], v27 offset:3072
    s_cmp_ge_u32 s5, 4
    s_cselect_b32 s10, 1.0, 0x3eb8aa3b
    s_cselect_b32 s11, 1024, 0
    s_cselect_b32 s12, 6, 4
    s_lshl_b32 s12, s12, 7
    s_bitcmp1_b32 s5, 0
    s_cselect_b32 s12, s12, 0
    s_add_u32 s11, s11, s12
    s_bfe_u32 s12, s5, 0x10001
    s_lshl_b32 s13, s4, 1
    s_add_u32 s12, s12, s13
    s_mul_i32 s12, s12, 2816
    s_add_u32 s11, s11, s12
    s_add_u32 s11, s11, 147456
    v_lshlrev_b32 v6, 5, v4
    v_lshl_add_u32 v6, v5, 3, v6
    s_waitcnt lgkmcnt(0)
    v_add_f32 v48, v48, v52
    v_add_f32 v49, v49, v53
    v_add_f32 v50, v50, v54
    v_add_f32 v51, v51, v55
    v_add_f32 v56, v56, v60
    v_add_f32 v57, v57, v61
    v_add_f32 v58, v58, v62
    v_add_f32 v59, v59, v63
    v_add_f32 v48, v48, v56
    v_add_f32 v49, v49, v57
    v_add_f32 v50, v50, v58
    v_add_f32 v51, v51, v59
    v_mul_f32 v48, s10, v48
    v_mul_f32 v49, s10, v49
    v_mul_f32 v50, s10, v50
    v_mul_f32 v51, s10, v51
    v_cvt_pk_bf16_f32 v52, v48, v49
    v_cvt_pk_bf16_f32 v53, v50, v51
    buffer_store_dwordx2 v[52:53], v6, s[64:67], s11 offen sc1
    v_add_u32 v56, v52, v53
    v_add_u32 v57, v52, v53
    s_add_u32 s13, s50, 0x9e3779b9
    s_and_b32 s10, s5, 1
    s_mul_i32 s10, s10, 384
    s_sub_u32 s10, 2560, s10
    v_permlane16_swap_b32 v56, v57
    s_cmp_ge_u32 s5, 4
    s_cselect_b32 s10, 640, s10
    s_add_u32 s10, s10, s11
    v_add_u32 v56, v56, v57
    v_sub_u32 v56, s13, v56
    v_lshrrev_b32 v57, 5, v0
    v_lshlrev_b32 v57, 2, v57
    v_lshl_add_u32 v57, v4, 3, v57
    s_mov_b32 exec_lo, 0xffff
    s_mov_b32 exec_hi, 0xffff
    buffer_store_dword v56, v57, s[64:67], s10 offen sc1
    s_mov_b64 exec, -1
    s_cmp_ge_u32 s5, 4
    s_cbranch_scc0 L_kv_noones
    v_mov_b32 v54, 0x3f803f80
    v_mov_b32 v55, 0x3f803f80
    s_sub_u32 s13, s13, 4261477888
    v_writelane_b32 v54, s13, 4
    v_writelane_b32 v55, s13, 4
    v_lshlrev_b32 v7, 3, v0
    s_mov_b64 exec, 0xffff
    buffer_store_dwordx2 v[54:55], v7, s[64:67], s11 offen offset:512 sc1
    s_mov_b64 exec, -1
L_kv_noones:
    s_mov_b64 exec, 1
    ds_add_u32 v1, v2 offset:84
    s_mov_b64 exec, -1
    s_mov_b32 s41, 1
L_kv_done:
    ds_write_b128 v64, v[8:11]
    ds_write_b128 v65, v[12:15]
    ds_write_b128 v66, v[16:19]
    ds_write_b128 v67, v[20:23]
    s_waitcnt lgkmcnt(0)
    s_mov_b64 exec, 1
    ds_add_u32 v1, v2 offset:96
    s_mov_b64 exec, -1
    s_cmp_eq_u32 s41, 1
    s_cbranch_scc0 Lkf_1
    s_lshl_b32 s10, s4, 3
    s_add_u32 s10, s10, s5
    s_lshl_b32 s10, s10, 5
    s_add_u32 s10, s10, 4096
    s_add_u32 s11, s50, 0x9e3779b9
    v_mov_b32 v74, s11
    v_mov_b32 v75, 0
    s_waitcnt vmcnt(0)
    s_mov_b64 exec, 1
    buffer_store_dword v74, v75, s[64:67], s10 offen sc1
    s_mov_b64 exec, -1
Lkf_1:
Lw_2:
    ds_read_b32 v3, v1 offset:96
    s_waitcnt lgkmcnt(0)
    v_readfirstlane_b32 s8, v3
    s_nop 2
    s_cmp_ge_u32 s8, 8
    s_cbranch_scc1 Ld_3
    s_sub_u32 s51, s51, 1
    s_cbranch_scc0 Lw_2
    s_mov_b32 s51, 0
Ld_3:
    ds_read_b128 v[8:11], v152 offset:0
    ds_read_b128 v[12:15], v152 offset:16384
    ds_read_b128 v[16:19], v153 offset:0
    ds_read_b128 v[20:23], v153 offset:16384
    ds_read_b128 v[24:27], v154 offset:0
    ds_read_b128 v[28:31], v154 offset:16384
    ds_read_b128 v[32:35], v155 offset:0
    ds_read_b128 v[36:39], v155 offset:16384
    ds_read_b128 v[40:43], v152 offset:256
    ds_read_b128 v[44:47], v152 offset:16640
    ds_read_b128 v[48:51], v153 offset:256
    ds_read_b128 v[52:55], v153 offset:16640
    ds_read_b128 v[56:59], v154 offset:256
    ds_read_b128 v[60:63], v154 offset:16640
    ds_read_b128 v[64:67], v155 offset:256
    ds_read_b128 v[68:71], v155 offset:16640
Lw_4:
    ds_read_b32 v3, v1 offset:4
    s_waitcnt lgkmcnt(0)
    v_readfirstlane_b32 s8, v3
    s_nop 2
    s_cmp_ge_u32 s8, 4
    s_cbranch_scc1 Ld_5
    s_sub_u32 s51, s51, 1
    s_cbranch_scc0 Lw_4
    s_mov_b32 s51, 0
Ld_5:
    ds_read_b64_tr_b16 v[76:77], v156 offset:0
    ds_read_b64_tr_b16 v[78:79], v156 offset:512
    ds_read_b64_tr_b16 v[80:81], v156 offset:4096
    ds_read_b64_tr_b16 v[82:83], v156 offset:4608
    ds_read_b64_tr_b16 v[84:85], v156 offset:8192
    ds_read_b64_tr_b16 v[86:87], v156 offset:8704
    s_waitcnt lgkmcnt(4)
    v_mfma_f32_16x16x32_bf16 v[140:143], v[76:79], v[8:11], 0
    v_mfma_f32_16x16x32_bf16 v[144:147], v[76:79], v[12:15], 0
    ds_read_b64_tr_b16 v[88:89], v156 offset:12288
    ds_read_b64_tr_b16 v[90:91], v156 offset:12800
    ds_read_b128 v[8:11], v152 offset:512
    ds_read_b128 v[12:15], v152 offset:16896
    s_waitcnt lgkmcnt(6)
    v_mfma_f32_16x16x32_bf16 v[140:143], v[80:83], v[16:19], v[140:143]
    v_mfma_f32_16x16x32_bf16 v[144:147], v[80:83], v[20:23], v[144:147]
    ds_read_b64_tr_b16 v[92:93], v156 offset:16384
    ds_read_b64_tr_b16 v[94:95], v156 offset:16896
    ds_read_b128 v[16:19], v153 offset:512
    ds_read_b128 v[20:23], v153 offset:16896
    s_waitcnt lgkmcnt(8)
    v_mfma_f32_16x16x32_bf16 v[140:143], v[84:87], v[24:27], v[140:143]
    v_mfma_f32_16x16x32_bf16 v[144:147], v[84:87], v[28:31], v[144:147]
    ds_read_b64_tr_b16 v[96:97], v156 offset:20480
    ds_read_b64_tr_b16 v[98:99], v156 offset:20992
    ds_read_b128 v[24:27], v154 offset:512
    ds_read_b128 v[28:31], v154 offset:16896
    s_waitcnt lgkmcnt(10)
    v_mfma_f32_16x16x32_bf16 v[140:143], v[88:91], v[32:35], v[140:143]
    v_mfma_f32_16x16x32_bf16 v[144:147], v[88:91], v[36:39], v[144:147]
    ds_read_b64_tr_b16 v[100:101], v156 offset:24576
    ds_read_b64_tr_b16 v[102:103], v156 offset:25088
    ds_read_b128 v[32:35], v155 offset:512
    ds_read_b128 v[36:39], v155 offset:16896
    s_waitcnt lgkmcnt(10)
    v_mfma_f32_16x16x32_bf16 v[140:143], v[92:95], v[40:43], v[140:143]
    v_mfma_f32_16x16x32_bf16 v[144:147], v[92:95], v[44:47], v[144:147]
    ds_read_b64_tr_b16 v[104:105], v156 offset:28672
    ds_read_b64_tr_b16 v[106:107], v156 offset:29184
    ds_read_b128 v[40:43], v152 offset:768
    ds_read_b128 v[44:47], v152 offset:17152
    s_waitcnt lgkmcnt(10)
    v_mfma_f32_16x16x32_bf16 v[140:143], v[96:99], v[48:51], v[140:143]
    v_mfma_f32_16x16x32_bf16 v[144:147], v[96:99], v[52:55], v[144:147]
    ds_read_b128 v[48:51], v153 offset:768
    ds_read_b128 v[52:55], v153 offset:17152
    s_waitcnt lgkmcnt(8)
    v_mfma_f32_16x16x32_bf16 v[140:143], v[100:103], v[56:59], v[140:143]
    v_mfma_f32_16x16x32_bf16 v[144:147], v[100:103], v[60:63], v[144:147]
    ds_read_b128 v[56:59], v154 offset:768
    ds_read_b128 v[60:63], v154 offset:17152
    s_waitcnt lgkmcnt(6)
    v_mfma_f32_16x16x32_bf16 v[140:143], v[104:107], v[64:67], v[140:143]
    v_mfma_f32_16x16x32_bf16 v[144:147], v[104:107], v[68:71], v[144:147]
    ds_read_b128 v[64:67], v155 offset:768
    ds_read_b128 v[68:71], v155 offset:17152
Lw_6:
    ds_read_b32 v3, v1 offset:8
    s_waitcnt lgkmcnt(0)
    v_readfirstlane_b32 s8, v3
    s_nop 2
    s_cmp_ge_u32 s8, 4
    s_cbranch_scc1 Ld_7
    s_sub_u32 s51, s51, 1
    s_cbranch_scc0 Lw_6
    s_mov_b32 s51, 0
Ld_7:
    ds_read_b64_tr_b16 v[108:109], v156 offset:32768
    ds_read_b64_tr_b16 v[110:111], v156 offset:33280
    ds_read_b64_tr_b16 v[112:113], v156 offset:36864
    ds_read_b64_tr_b16 v[114:115], v156 offset:37376
    ds_read_b64_tr_b16 v[116:117], v156 offset:40960
    ds_read_b64_tr_b16 v[118:119], v156 offset:41472
    ds_read_b64_tr_b16 v[120:121], v156 offset:45056
    ds_read_b64_tr_b16 v[122:123], v156 offset:45568
    ds_read_b64_tr_b16 v[124:125], v156 offset:49152
    ds_read_b64_tr_b16 v[126:127], v156 offset:49664
    ds_read_b64_tr_b16 v[128:129], v156 offset:53248
    ds_read_b64_tr_b16 v[130:131], v156 offset:53760
    s_waitcnt lgkmcnt(10)
    v_mfma_f32_16x16x32_bf16 v[140:143], v[108:111], v[8:11], v[140:143]
    v_mfma_f32_16x16x32_bf16 v[144:147], v[108:111], v[12:15], v[144:147]
    ds_read_b64_tr_b16 v[132:133], v156 offset:57344
    ds_read_b64_tr_b16 v[134:135], v156 offset:57856
    s_waitcnt lgkmcnt(10)
    v_mfma_f32_16x16x32_bf16 v[140:143], v[112:115], v[16:19], v[140:143]
    v_mfma_f32_16x16x32_bf16 v[144:147], v[112:115], v[20:23], v[144:147]
    ds_read_b64_tr_b16 v[136:137], v156 offset:61440
    ds_read_b64_tr_b16 v[138:139], v156 offset:61952
    s_waitcnt lgkmcnt(10)
    v_mfma_f32_16x16x32_bf16 v[140:143], v[116:119], v[24:27], v[140:143]
    v_mfma_f32_16x16x32_bf16 v[144:147], v[116:119], v[28:31], v[144:147]
    s_waitcnt lgkmcnt(8)
    v_mfma_f32_16x16x32_bf16 v[140:143], v[120:123], v[32:35], v[140:143]
    v_mfma_f32_16x16x32_bf16 v[144:147], v[120:123], v[36:39], v[144:147]
    s_waitcnt lgkmcnt(6)
    v_mfma_f32_16x16x32_bf16 v[140:143], v[124:127], v[40:43], v[140:143]
    v_mfma_f32_16x16x32_bf16 v[144:147], v[124:127], v[44:47], v[144:147]
    s_waitcnt lgkmcnt(4)
    v_mfma_f32_16x16x32_bf16 v[140:143], v[128:131], v[48:51], v[140:143]
    v_mfma_f32_16x16x32_bf16 v[144:147], v[128:131], v[52:55], v[144:147]
    s_waitcnt lgkmcnt(2)
    v_mfma_f32_16x16x32_bf16 v[140:143], v[132:135], v[56:59], v[140:143]
    v_mfma_f32_16x16x32_bf16 v[144:147], v[132:135], v[60:63], v[144:147]
    s_waitcnt lgkmcnt(0)
    v_mfma_f32_16x16x32_bf16 v[140:143], v[136:139], v[64:67], v[140:143]
    v_mfma_f32_16x16x32_bf16 v[144:147], v[136:139], v[68:71], v[144:147]
    s_nop 6
    v_cvt_pk_bf16_f32 v148, v140, v141
    v_cvt_pk_bf16_f32 v149, v142, v143
    v_cvt_pk_bf16_f32 v150, v144, v145
    v_cvt_pk_bf16_f32 v151, v146, v147
    ds_write_b64 v157, v[148:149] offset:0
    ds_write_b64 v157, v[150:151] offset:256
    s_waitcnt lgkmcnt(0)
    s_mov_b64 exec, 1
    ds_add_rtn_u32 v3, v1, v2 offset:16
    s_mov_b64 exec, -1
    s_waitcnt lgkmcnt(0)
    v_readfirstlane_b32 s8, v3
    s_nop 2
    s_cmp_eq_u32 s8, 3
    s_cbranch_scc1 Ls_8
Lw_9:
    ds_read_b32 v3, v1 offset:16
    s_waitcnt lgkmcnt(0)
    v_readfirstlane_b32 s8, v3
    s_nop 2
    s_cmp_ge_u32 s8, 4
    s_cbranch_scc1 Ld_10
    s_sleep 1
    s_sub_u32 s51, s51, 1
    s_cbranch_scc0 Lw_9
    s_mov_b32 s51, 0
Ld_10:
Ls_8:
    s_bfe_u32 s11, s5, 0x10001
    s_xor_b32 s11, s11, 1
    s_lshl_b32 s11, s11, 15
    s_lshl_b32 s9, s4, 16
    s_add_u32 s9, s9, s11
    s_lshl_b32 s10, s7, 13
    s_and_b32 s11, s7, 1
    s_lshl_b32 s11, s11, 7
    s_add_u32 s9, s9, s10
    s_add_u32 m0, s10, 32768
    v_lshlrev_b32 v12, 4, v0
    v_xor_b32 v12, s11, v12
    buffer_load_dwordx4 v12, s[52:55], s9 offen lds
    v_xor_b32 v14, 16, v12
    buffer_load_dwordx4 v14, s[52:55], s9 offen offset:1024 lds
    v_xor_b32 v13, 32, v12
    buffer_load_dwordx4 v13, s[52:55], s9 offen offset:2048 lds
    v_xor_b32 v14, 48, v12
    buffer_load_dwordx4 v14, s[52:55], s9 offen offset:3072 lds
    s_add_u32 s9, s9, 4096
    s_add_u32 m0, m0, 4096
    v_xor_b32 v13, 64, v12
    buffer_load_dwordx4 v13, s[52:55], s9 offen offset:0 lds
    v_xor_b32 v14, 80, v12
    buffer_load_dwordx4 v14, s[52:55], s9 offen offset:1024 lds
    v_xor_b32 v13, 96, v12
    buffer_load_dwordx4 v13, s[52:55], s9 offen offset:2048 lds
    v_xor_b32 v14, 112, v12
    buffer_load_dwordx4 v14, s[52:55], s9 offen offset:3072 lds
    s_waitcnt vmcnt(0)
    s_mov_b64 exec, 1
    ds_add_rtn_u32 v3, v1, v2 offset:12
    s_mov_b64 exec, -1
    s_waitcnt lgkmcnt(0)
    v_readfirstlane_b32 s8, v3
    s_nop 2
    s_cmp_eq_u32 s8, 3
    s_cbranch_scc1 Ls_11
Lw_12:
    ds_read_b32 v3, v1 offset:12
    s_waitcnt lgkmcnt(0)
    v_readfirstlane_b32 s8, v3
    s_nop 2
    s_cmp_ge_u32 s8, 4
    s_cbranch_scc1 Ld_13
    s_sleep 1
    s_sub_u32 s51, s51, 1
    s_cbranch_scc0 Lw_12
    s_mov_b32 s51, 0
Ld_13:
Ls_11:
    ds_read_b128 v[8:11], v152 offset:0
    ds_read_b128 v[12:15], v152 offset:16384
    ds_read_b128 v[16:19], v153 offset:0
    ds_read_b128 v[20:23], v153 offset:16384
    ds_read_b128 v[24:27], v154 offset:0
    ds_read_b128 v[28:31], v154 offset:16384
    ds_read_b128 v[32:35], v155 offset:0
    ds_read_b128 v[36:39], v155 offset:16384
    ds_read_b128 v[40:43], v152 offset:256
    ds_read_b128 v[44:47], v152 offset:16640
    ds_read_b128 v[48:51], v153 offset:256
    ds_read_b128 v[52:55], v153 offset:16640
    s_waitcnt lgkmcnt(10)
    v_mfma_f32_16x16x32_bf16 v[140:143], v[76:79], v[8:11], 0
    v_mfma_f32_16x16x32_bf16 v[144:147], v[76:79], v[12:15], 0
    ds_read_b128 v[56:59], v154 offset:256
    ds_read_b128 v[60:63], v154 offset:16640
    s_waitcnt lgkmcnt(10)
    v_mfma_f32_16x16x32_bf16 v[140:143], v[80:83], v[16:19], v[140:143]
    v_mfma_f32_16x16x32_bf16 v[144:147], v[80:83], v[20:23], v[144:147]
    ds_read_b128 v[64:67], v155 offset:256
    ds_read_b128 v[68:71], v155 offset:16640
    s_waitcnt lgkmcnt(10)
    v_mfma_f32_16x16x32_bf16 v[140:143], v[84:87], v[24:27], v[140:143]
    v_mfma_f32_16x16x32_bf16 v[144:147], v[84:87], v[28:31], v[144:147]
    ds_read_b128 v[8:11], v152 offset:512
    ds_read_b128 v[12:15], v152 offset:16896
    s_waitcnt lgkmcnt(10)
    v_mfma_f32_16x16x32_bf16 v[140:143], v[88:91], v[32:35], v[140:143]
    v_mfma_f32_16x16x32_bf16 v[144:147], v[88:91], v[36:39], v[144:147]
    ds_read_b128 v[16:19], v153 offset:512
    ds_read_b128 v[20:23], v153 offset:16896
    s_waitcnt lgkmcnt(10)
    v_mfma_f32_16x16x32_bf16 v[140:143], v[92:95], v[40:43], v[140:143]
    v_mfma_f32_16x16x32_bf16 v[144:147], v[92:95], v[44:47], v[144:147]
    ds_read_b128 v[24:27], v154 offset:512
    ds_read_b128 v[28:31], v154 offset:16896
    s_waitcnt lgkmcnt(10)
    v_mfma_f32_16x16x32_bf16 v[140:143], v[96:99], v[48:51], v[140:143]
    v_mfma_f32_16x16x32_bf16 v[144:147], v[96:99], v[52:55], v[144:147]
    ds_read_b128 v[32:35], v155 offset:512
    ds_read_b128 v[36:39], v155 offset:16896
    s_waitcnt lgkmcnt(10)
    v_mfma_f32_16x16x32_bf16 v[140:143], v[100:103], v[56:59], v[140:143]
    v_mfma_f32_16x16x32_bf16 v[144:147], v[100:103], v[60:63], v[144:147]
    ds_read_b128 v[40:43], v152 offset:768
    ds_read_b128 v[44:47], v152 offset:17152
    s_waitcnt lgkmcnt(10)
    v_mfma_f32_16x16x32_bf16 v[140:143], v[104:107], v[64:67], v[140:143]
    v_mfma_f32_16x16x32_bf16 v[144:147], v[104:107], v[68:71], v[144:147]
    ds_read_b128 v[48:51], v153 offset:768
    ds_read_b128 v[52:55], v153 offset:17152
    s_waitcnt lgkmcnt(10)
    v_mfma_f32_16x16x32_bf16 v[140:143], v[108:111], v[8:11], v[140:143]
    v_mfma_f32_16x16x32_bf16 v[144:147], v[108:111], v[12:15], v[144:147]
    ds_read_b128 v[56:59], v154 offset:768
    ds_read_b128 v[60:63], v154 offset:17152
    s_waitcnt lgkmcnt(10)
    v_mfma_f32_16x16x32_bf16 v[140:143], v[112:115], v[16:19], v[140:143]
    v_mfma_f32_16x16x32_bf16 v[144:147], v[112:115], v[20:23], v[144:147]
    ds_read_b128 v[64:67], v155 offset:768
    ds_read_b128 v[68:71], v155 offset:17152
    s_waitcnt lgkmcnt(10)
    v_mfma_f32_16x16x32_bf16 v[140:143], v[116:119], v[24:27], v[140:143]
    v_mfma_f32_16x16x32_bf16 v[144:147], v[116:119], v[28:31], v[144:147]
    s_waitcnt lgkmcnt(8)
    v_mfma_f32_16x16x32_bf16 v[140:143], v[120:123], v[32:35], v[140:143]
    v_mfma_f32_16x16x32_bf16 v[144:147], v[120:123], v[36:39], v[144:147]
    s_waitcnt lgkmcnt(6)
    v_mfma_f32_16x16x32_bf16 v[140:143], v[124:127], v[40:43], v[140:143]
    v_mfma_f32_16x16x32_bf16 v[144:147], v[124:127], v[44:47], v[144:147]
    s_waitcnt lgkmcnt(4)
    v_mfma_f32_16x16x32_bf16 v[140:143], v[128:131], v[48:51], v[140:143]
    v_mfma_f32_16x16x32_bf16 v[144:147], v[128:131], v[52:55], v[144:147]
    s_waitcnt lgkmcnt(2)
    v_mfma_f32_16x16x32_bf16 v[140:143], v[132:135], v[56:59], v[140:143]
    v_mfma_f32_16x16x32_bf16 v[144:147], v[132:135], v[60:63], v[144:147]
    s_waitcnt lgkmcnt(0)
    v_mfma_f32_16x16x32_bf16 v[140:143], v[136:139], v[64:67], v[140:143]
    v_mfma_f32_16x16x32_bf16 v[144:147], v[136:139], v[68:71], v[144:147]
    s_nop 6
    v_cvt_pk_bf16_f32 v148, v140, v141
    v_cvt_pk_bf16_f32 v149, v142, v143
    v_cvt_pk_bf16_f32 v150, v144, v145
    v_cvt_pk_bf16_f32 v151, v146, v147
    ds_write_b64 v157, v[148:149] offset:4096
    ds_write_b64 v157, v[150:151] offset:4352
    s_waitcnt lgkmcnt(0)
    s_mov_b64 exec, 1
    ds_add_u32 v1, v2 offset:20
    s_mov_b64 exec, -1
    s_branch L_att_setup
L_role_early:
    s_setprio 3
    v_lshl_add_u32 v4, v0, 2, v1
    v_mov_b32 v5, 0
    ds_write_b32 v4, v5
    s_waitcnt lgkmcnt(0)
    s_mov_b32 s64, s48
    s_mov_b32 s65, s49
    s_mov_b32 s52, s16
    s_mov_b32 s53, s17
    s_mov_b32 s56, s18
    s_mov_b32 s57, s19
    s_mov_b32 s58, 524288
    s_bfe_u32 s11, s5, 0x10001
    s_xor_b32 s11, s11, 0
    s_lshl_b32 s11, s11, 15
    s_lshl_b32 s9, s4, 16
    s_add_u32 s9, s9, s11
    s_lshl_b32 s10, s7, 12
    s_and_b32 s11, s5, 1
    s_xor_b32 s11, s11, 1
    s_lshl_b32 s11, s11, 14
    s_add_u32 s10, s10, s11
    s_lshl_b32 s11, s7, 6
    s_add_u32 s9, s9, s10
    s_add_u32 m0, s10, 32768
    v_lshlrev_b32 v12, 4, v0
    v_xor_b32 v12, s11, v12
    buffer_load_dwordx4 v12, s[52:55], s9 offen lds
    v_xor_b32 v14, 16, v12
    buffer_load_dwordx4 v14, s[52:55], s9 offen offset:1024 lds
    v_xor_b32 v13, 32, v12
    buffer_load_dwordx4 v13, s[52:55], s9 offen offset:2048 lds
    v_xor_b32 v14, 48, v12
    buffer_load_dwordx4 v14, s[52:55], s9 offen offset:3072 lds
    s_and_b32 s12, s6, 31
    s_lshl_b32 s12, s12, 2
    s_add_u32 s12, s12, s7
    s_lshl_b32 s12, s12, 12
    v_lshlrev_b32 v10, 10, v0
    s_mov_b64 exec, 0xf
    buffer_load_dword v11, v10, s[56:59], s12 offen offset:384
    s_mov_b64 exec, -1
    v_lshrrev_b32 v15, 3, v0
    v_and_b32 v16, 7, v0
    v_and_b32 v17, 2, v15
    v_xor_b32 v16, v16, v17
    s_and_b32 s11, s7, 1
    s_lshl_b32 s11, s11, 2
    v_xor_b32 v16, s11, v16
    v_lshlrev_b32 v15, 10, v15
    v_lshl_add_u32 v15, v16, 4, v15
    s_lshl_b32 s9, s7, 13
    s_lshl_b32 s10, s5, 7
    s_add_u32 s9, s9, s10
    s_lshl_b32 s10, s7, 10
    s_add_u32 m0, s10, 65536
    s_mov_b32 s42, s9
    s_mul_i32 s10, s7, 45056
    s_add_u32 s10, s10, 147456
    v_and_b32 v7, 31, v0
    v_lshrrev_b32 v8, 5, v0
    v_lshlrev_b32 v4, 5, v7
    v_lshl_add_u32 v4, v8, 4, v4
    v_and_b32 v9, 3, v7
    v_bfe_u32 v10, v7, 2, 1
    v_lshl_add_u32 v9, v10, 3, v9
    v_bfe_u32 v10, v7, 3, 1
    v_lshl_add_u32 v9, v10, 2, v9
    v_lshlrev_b32 v9, 5, v9
    s_mov_b32 s12, 0xffff
    s_mov_b32 s13, 0xffff
    v_mov_b32 v10, 2146435072
    v_cndmask_b32 v9, v10, v9, s[12:13]
    s_mov_b32 s12, 0x110000
    s_mov_b32 s13, 0x110000
    v_mov_b32 v10, 512
    v_cndmask_b32 v9, v9, v10, s[12:13]
    v_lshl_add_u32 v5, v8, 4, v9
    v_lshrrev_b32 v96, 2, v4
    v_add_u32 v96, s10, v96
    v_lshrrev_b32 v104, 2, v5
    v_add_u32 v9, 640, v104
    v_add_u32 v104, 416, v104
    s_mov_b32 s12, 0xffff
    s_mov_b32 s13, 0xffff
    v_cndmask_b32 v104, v104, v9, s[12:13]
    v_add_u32 v104, s10, v104
    v_add_u32 v4, s10, v4
    v_add_u32 v5, s10, v5
    s_add_u32 s10, s7, 0
    s_and_b32 s10, s10, 3
    s_mul_i32 s28, s10, 6912
    s_add_u32 s10, s7, 1
    s_and_b32 s10, s10, 3
    s_mul_i32 s29, s10, 6912
    s_add_u32 s10, s7, 2
    s_and_b32 s10, s10, 3
    s_mul_i32 s30, s10, 6912
    s_add_u32 s10, s7, 3
    s_and_b32 s10, s10, 3
    s_mul_i32 s31, s10, 6912
    s_cmp_eq_u32 s14, 0
    s_cselect_b32 s10, 32768, 0
    s_add_u32 s28, s28, s10
    s_add_u32 s29, s29, s10
    s_add_u32 s30, s30, s10
    s_add_u32 s31, s31, s10
    s_lshl_b32 s11, s4, 1
    s_add_u32 s11, s11, s14
    s_lshl_b32 s11, s11, 5
    s_lshl_b32 s12, s5, 2
    s_add_u32 s11, s11, s12
    s_add_u32 s11, s11, s7
    s_lshl_b32 s11, s11, 10
    s_add_u32 s32, s11, 524288
    s_cmp_eq_u32 s14, 0
    s_mov_b32 s33, 19
    s_cselect_b32 s34, 11, 13
    s_lshl_b32 s33, s33, 2
    s_lshl_b32 s34, s34, 2
    s_add_u32 s33, s33, 159744
    s_add_u32 s34, s34, 159744
    s_cmp_eq_u32 s14, 0
    s_cselect_b32 s35, 4, 7
    s_lshl_b32 s35, 1, s35
    s_lshl_b32 s10, s14, 12
    s_add_u32 s10, s10, 147456
    v_lshl_add_u32 v7, v0, 4, s10
    s_add_u32 s11, s7, 0
    s_and_b32 s11, s11, 3
    s_lshl_b32 s11, s11, 10
    v_add_u32 v160, s11, v7
    s_add_u32 s11, s7, 1
    s_and_b32 s11, s11, 3
    s_lshl_b32 s11, s11, 10
    v_add_u32 v161, s11, v7
    s_add_u32 s11, s7, 2
    s_and_b32 s11, s11, 3
    s_lshl_b32 s11, s11, 10
    v_add_u32 v162, s11, v7
    s_add_u32 s11, s7, 3
    s_and_b32 s11, s11, 3
    s_lshl_b32 s11, s11, 10
    v_add_u32 v163, s11, v7
    s_mul_i32 s36, s15, 2816
    s_add_u32 s15, s15, 1
    s_and_b32 s15, s15, 15
    s_mul_i32 s37, s15, 2816
    s_add_u32 s15, s15, 1
    s_and_b32 s15, s15, 15
    s_mul_i32 s38, s15, 2816
    s_add_u32 s15, s15, 1
    s_and_b32 s15, s15, 15
    s_mul_i32 s39, s15, 2816
    s_mov_b32 s69, 2146435072
    s_lshl_b32 s10, s14, 2
    v_add_u32 v92, s10, v1
    v_mov_b32 v6, 0xdddddddd
    v_mov_b32 v7, s33
    v_mov_b64 v[24:25], 0
    v_mov_b64 v[26:27], 0
    v_mov_b64 v[28:29], 0
    v_mov_b64 v[30:31], 0
    v_mov_b64 v[32:33], 0
    v_mov_b64 v[34:35], 0
    v_mov_b64 v[36:37], 0
    v_mov_b64 v[38:39], 0
    v_mov_b64 v[40:41], 0
    v_mov_b64 v[42:43], 0
    v_mov_b64 v[44:45], 0
    v_mov_b64 v[46:47], 0
    v_mov_b64 v[48:49], 0
    v_mov_b64 v[50:51], 0
    v_mov_b64 v[52:53], 0
    v_mov_b64 v[54:55], 0
    v_mov_b64 v[56:57], 0
    v_mov_b64 v[58:59], 0
    v_mov_b64 v[60:61], 0
    v_mov_b64 v[62:63], 0
    v_mov_b64 v[64:65], 0
    v_mov_b64 v[66:67], 0
    v_mov_b64 v[68:69], 0
    v_mov_b64 v[70:71], 0
    v_mov_b64 v[72:73], 0
    v_mov_b64 v[74:75], 0
    v_mov_b64 v[76:77], 0
    v_mov_b64 v[78:79], 0
    v_mov_b64 v[80:81], 0
    v_mov_b64 v[82:83], 0
    v_mov_b64 v[84:85], 0
    v_mov_b64 v[86:87], 0
    v_mov_b64 v[112:113], 0
    v_mov_b64 v[114:115], 0
    v_mov_b64 v[116:117], 0
    v_mov_b64 v[118:119], 0
    v_mov_b64 v[164:165], 0
    v_mov_b64 v[166:167], 0
    s_mov_b32 s9, s42
    s_barrier
    buffer_load_dwordx4 v15, s[56:59], s9 offen lds
    s_add_u32 m0, m0, 4096
    s_add_u32 s9, s9, 32768
    buffer_load_dwordx4 v15, s[56:59], s9 offen lds
    s_add_u32 m0, m0, 4096
    s_add_u32 s9, s9, 32768
    buffer_load_dwordx4 v15, s[56:59], s9 offen lds
    s_add_u32 m0, m0, 4096
    s_add_u32 s9, s9, 32768
    buffer_load_dwordx4 v15, s[56:59], s9 offen lds
    s_add_u32 m0, m0, 4096
    s_add_u32 s9, s9, 32768
    buffer_load_dwordx4 v15, s[56:59], s9 offen lds
    s_add_u32 m0, m0, 4096
    s_add_u32 s9, s9, 32768
    buffer_load_dwordx4 v15, s[56:59], s9 offen lds
    s_add_u32 m0, m0, 4096
    s_add_u32 s9, s9, 32768
    buffer_load_dwordx4 v15, s[56:59], s9 offen lds
    s_add_u32 m0, m0, 4096
    s_add_u32 s9, s9, 32768
    buffer_load_dwordx4 v15, s[56:59], s9 offen lds
    s_add_u32 m0, m0, 4096
    s_add_u32 s9, s9, 32768
    s_waitcnt vmcnt(9)
    s_mov_b64 exec, 1
    ds_add_u32 v1, v2 offset:96
    s_mov_b64 exec, -1
Lw_14:
    ds_read_b32 v3, v1 offset:84
    s_waitcnt lgkmcnt(0)
    v_readfirstlane_b32 s8, v3
    s_nop 2
    s_cmp_ge_u32 s8, 1
    s_cbranch_scc1 Ld_15
    s_sleep 1
    s_sub_u32 s51, s51, 1
    s_cbranch_scc0 Lw_14
    s_mov_b32 s51, 0
Ld_15:
    buffer_load_dwordx4 v15, s[56:59], s9 offen lds
    s_add_u32 m0, m0, 4096
    s_add_u32 s9, s9, 32768
    buffer_load_dwordx4 v15, s[56:59], s9 offen lds
    s_add_u32 m0, m0, 4096
    s_add_u32 s9, s9, 32768
    buffer_load_dwordx4 v15, s[56:59], s9 offen lds
    s_add_u32 m0, m0, 4096
    s_add_u32 s9, s9, 32768
    buffer_load_dwordx4 v15, s[56:59], s9 offen lds
    s_add_u32 m0, m0, 4096
    s_add_u32 s9, s9, 32768
    buffer_load_dwordx4 v15, s[56:59], s9 offen lds
    s_add_u32 m0, m0, 4096
    s_add_u32 s9, s9, 32768
    buffer_load_dwordx4 v15, s[56:59], s9 offen lds
    s_add_u32 m0, m0, 4096
    s_add_u32 s9, s9, 32768
    buffer_load_dwordx4 v15, s[56:59], s9 offen lds
    s_add_u32 m0, m0, 4096
    s_add_u32 s9, s9, 32768
    buffer_load_dwordx4 v15, s[56:59], s9 offen lds
Lw_16:
    ds_read_b32 v3, v1 offset:0
    s_waitcnt lgkmcnt(0)
    v_readfirstlane_b32 s8, v3
    s_nop 2
    s_cmp_ge_u32 s8, 4
    s_cbranch_scc1 Ld_17
    s_sleep 1
    s_sub_u32 s51, s51, 1
    s_cbranch_scc0 Lw_16
    s_mov_b32 s51, 0
Ld_17:
    ds_read_b32 v103, v1 offset:128
    s_waitcnt lgkmcnt(0)
    v_readfirstlane_b32 s50, v103
    s_waitcnt vmcnt(8)
    s_mov_b64 exec, 1
    ds_add_u32 v1, v2 offset:4
    s_mov_b64 exec, -1
    s_waitcnt vmcnt(0)
    s_mov_b64 exec, 1
    ds_add_u32 v1, v2 offset:8
    s_mov_b64 exec, -1
L_val:
    buffer_load_dwordx4 v[120:123], v4, s[64:67], s36 offen offset:0 sc1
    buffer_load_dword v97, v96, s[64:67], s36 offen offset:2560 sc1
    buffer_load_dwordx4 v[124:127], v5, s[64:67], s36 offen offset:1024 sc1
    buffer_load_dword v98, v104, s[64:67], s36 offen offset:1024 sc1
    buffer_load_dwordx4 v[128:131], v5, s[64:67], s36 offen offset:1792 sc1
    buffer_load_dword v99, v104, s[64:67], s36 offen offset:1792 sc1
    buffer_load_dwordx4 v[132:135], v4, s[64:67], s37 offen offset:0 sc1
    buffer_load_dword v100, v96, s[64:67], s37 offen offset:2560 sc1
    buffer_load_dwordx4 v[136:139], v5, s[64:67], s37 offen offset:1024 sc1
    buffer_load_dword v101, v104, s[64:67], s37 offen offset:1024 sc1
    buffer_load_dwordx4 v[140:143], v5, s[64:67], s37 offen offset:1792 sc1
    buffer_load_dword v102, v104, s[64:67], s37 offen offset:1792 sc1
L_val_chk:
    s_waitcnt vmcnt(10)
    v_add3_u32 v95, v120, v121, v122
    v_add3_u32 v95, v95, v123, v97
    v_xor_b32 v93, v103, v95
    s_waitcnt vmcnt(8)
    v_add3_u32 v95, v124, v125, v126
    v_add3_u32 v95, v95, v127, v98
    v_xor_b32 v94, v103, v95
    s_waitcnt vmcnt(6)
    v_add3_u32 v95, v128, v129, v130
    v_add3_u32 v95, v95, v131, v99
    v_bitop3_b32 v94, v94, v95, v103 bitop3:0xf6
    s_waitcnt vmcnt(4)
    v_add3_u32 v95, v132, v133, v134
    v_add3_u32 v95, v95, v135, v100
    v_bitop3_b32 v93, v93, v95, v103 bitop3:0xf6
    s_waitcnt vmcnt(2)
    v_add3_u32 v95, v136, v137, v138
    v_add3_u32 v95, v95, v139, v101
    v_bitop3_b32 v94, v94, v95, v103 bitop3:0xf6
    s_waitcnt vmcnt(0)
    v_add3_u32 v95, v140, v141, v142
    v_add3_u32 v95, v95, v143, v102
    v_bitop3_b32 v94, v94, v95, v103 bitop3:0xf6
    v_cmp_ne_u32 s[10:11], 0, v94
    v_cmp_ne_u32 vcc, 0, v93
    s_nop 1
    s_and_b32 s10, s10, 0x11ffff
    s_and_b32 s11, s11, 0x11ffff
    s_or_b64 vcc, vcc, s[10:11]
    s_cbranch_scc0 L_val_ok
    s_sub_u32 s51, s51, 1
    s_cbranch_scc0 L_val
    s_mov_b32 s51, 0
L_val_ok:
    s_lshl_b32 s40, s7, 11
    s_add_u32 s40, s40, 4096
    v_lshlrev_b32 v144, 5, v0
    buffer_load_dword v145, v144, s[64:67], s40 offen sc1
    s_branch L_att_go
L_att_setup:
    v_mov_b32 v4, v158
    v_mov_b32 v5, v159
    s_lshl_b32 s10, s14, 2
    v_add_u32 v92, s10, v1
    v_mov_b32 v6, 0xdddddddd
    v_mov_b32 v7, s33
    v_mov_b64 v[24:25], 0
    v_mov_b64 v[26:27], 0
    v_mov_b64 v[28:29], 0
    v_mov_b64 v[30:31], 0
    v_mov_b64 v[32:33], 0
    v_mov_b64 v[34:35], 0
    v_mov_b64 v[36:37], 0
    v_mov_b64 v[38:39], 0
    v_mov_b64 v[40:41], 0
    v_mov_b64 v[42:43], 0
    v_mov_b64 v[44:45], 0
    v_mov_b64 v[46:47], 0
    v_mov_b64 v[48:49], 0
    v_mov_b64 v[50:51], 0
    v_mov_b64 v[52:53], 0
    v_mov_b64 v[54:55], 0
    v_mov_b64 v[56:57], 0
    v_mov_b64 v[58:59], 0
    v_mov_b64 v[60:61], 0
    v_mov_b64 v[62:63], 0
    v_mov_b64 v[64:65], 0
    v_mov_b64 v[66:67], 0
    v_mov_b64 v[68:69], 0
    v_mov_b64 v[70:71], 0
    v_mov_b64 v[72:73], 0
    v_mov_b64 v[74:75], 0
    v_mov_b64 v[76:77], 0
    v_mov_b64 v[78:79], 0
    v_mov_b64 v[80:81], 0
    v_mov_b64 v[82:83], 0
    v_mov_b64 v[84:85], 0
    v_mov_b64 v[86:87], 0
    v_mov_b64 v[112:113], 0
    v_mov_b64 v[114:115], 0
    v_mov_b64 v[116:117], 0
    v_mov_b64 v[118:119], 0
    v_mov_b64 v[164:165], 0
    v_mov_b64 v[166:167], 0
Lw_18:
    ds_read_b32 v3, v1 offset:24
    s_waitcnt lgkmcnt(0)
    v_readfirstlane_b32 s8, v3
    s_nop 2
    s_cmp_ge_u32 s8, 4
    s_cbranch_scc1 Ld_19
    s_sleep 1
    s_sub_u32 s51, s51, 1
    s_cbranch_scc0 Lw_18
    s_mov_b32 s51, 0
Ld_19:
    buffer_load_dwordx4 v[120:123], v4, s[64:67], s36 offen offset:0 sc1
    buffer_load_dwordx4 v[124:127], v5, s[64:67], s36 offen offset:1024 sc1
    buffer_load_dwordx4 v[128:131], v5, s[64:67], s36 offen offset:1792 sc1
    buffer_load_dwordx4 v[132:135], v4, s[64:67], s37 offen offset:0 sc1
    buffer_load_dwordx4 v[136:139], v5, s[64:67], s37 offen offset:1024 sc1
    buffer_load_dwordx4 v[140:143], v5, s[64:67], s37 offen offset:1792 sc1
L_att_go:
Lw_20:
    ds_read_b32 v3, v92 offset:16
    s_waitcnt lgkmcnt(0)
    v_readfirstlane_b32 s8, v3
    s_nop 2
    s_cmp_ge_u32 s8, 4
    s_cbranch_scc1 Ld_21
    s_sub_u32 s51, s51, 1
    s_cbranch_scc0 Lw_20
    s_mov_b32 s51, 0
Ld_21:
    ds_read_b128 v[8:11], v160
    ds_read_b128 v[12:15], v161
    ds_read_b128 v[16:19], v162
    ds_read_b128 v[20:23], v163
    s_mov_b32 s68, 4
    s_waitcnt vmcnt(3) lgkmcnt(0)
    v_mfma_f32_32x32x16_bf16 v[88:103], v[120:123], v[8:11], 0
    s_nop 11
    s_setprio 2
    s_cmp_eq_u32 s14, 0
    s_cbranch_scc1 L_att0
    s_setprio 1
L_att0:
.p2align 6
L_att:
    v_exp_f32 v88, v88
    v_exp_f32 v89, v89
    v_smfmac_f32_32x32x32_bf16 v[72:87], v[164:167], v[112:119], v6
    buffer_load_dwordx4 v[164:167], v5, s[64:67], s69 offen offset:1792 sc1
    v_exp_f32 v90, v90
    v_exp_f32 v91, v91
    v_exp_f32 v92, v92
    v_mfma_f32_32x32x16_bf16 v[104:119], v[120:123], v[12:15], 0
    v_exp_f32 v93, v93
    v_exp_f32 v94, v94
    v_exp_f32 v95, v95
    v_exp_f32 v96, v96
    v_exp_f32 v97, v97
    v_exp_f32 v98, v98
    v_exp_f32 v99, v99
    v_smfmac_f32_32x32x32_bf16 v[24:39], v[124:127], v[88:95], v6
    v_exp_f32 v100, v100
    v_exp_f32 v101, v101
    v_exp_f32 v102, v102
    v_exp_f32 v103, v103
    v_exp_f32 v104, v104
    v_exp_f32 v105, v105
    v_smfmac_f32_32x32x32_bf16 v[24:39], v[128:131], v[96:103], v6
    s_add_u32 s15, s15, 1
    s_and_b32 s15, s15, 15
    s_mul_i32 s69, s15, 2816
    s_cmp_eq_u32 s68, 1
    s_cselect_b32 s69, 2146435072, s69
    v_exp_f32 v106, v106
    v_exp_f32 v107, v107
    v_exp_f32 v108, v108
    v_mfma_f32_32x32x16_bf16 v[88:103], v[120:123], v[16:19], 0
    v_exp_f32 v109, v109
    v_exp_f32 v110, v110
    v_exp_f32 v111, v111
    v_exp_f32 v112, v112
    v_exp_f32 v113, v113
    v_exp_f32 v114, v114
    v_exp_f32 v115, v115
    v_smfmac_f32_32x32x32_bf16 v[40:55], v[124:127], v[104:111], v6
    v_exp_f32 v116, v116
    v_exp_f32 v117, v117
    v_exp_f32 v118, v118
    v_exp_f32 v119, v119
    v_exp_f32 v88, v88
    v_exp_f32 v89, v89
    v_smfmac_f32_32x32x32_bf16 v[40:55], v[128:131], v[112:119], v6
    s_lshr_b32 s35, s35, 1
    s_bitcmp1_b32 s35, 0
    s_cbranch_scc0 Lp_22
    s_setprio 0
    s_cmp_eq_u32 s14, 0
    s_cbranch_scc0 Lp_22
    s_setprio 1
Lp_22:
    v_exp_f32 v90, v90
    v_exp_f32 v91, v91
    v_exp_f32 v92, v92
    v_mfma_f32_32x32x16_bf16 v[104:119], v[120:123], v[20:23], 0
    s_cmp_eq_u32 s68, 4
    s_cbranch_scc1 L_first
L_first_ret:
    buffer_load_dwordx4 v[120:123], v4, s[64:67], s69 offen offset:0 sc1
    v_exp_f32 v93, v93
    v_exp_f32 v94, v94
    v_exp_f32 v95, v95
    v_exp_f32 v96, v96
    v_exp_f32 v97, v97
    v_exp_f32 v98, v98
    v_exp_f32 v99, v99
    v_smfmac_f32_32x32x32_bf16 v[56:71], v[124:127], v[88:95], v6
    v_exp_f32 v100, v100
    v_exp_f32 v101, v101
    v_exp_f32 v102, v102
    v_exp_f32 v103, v103
    v_exp_f32 v104, v104
    v_exp_f32 v105, v105
    v_smfmac_f32_32x32x32_bf16 v[56:71], v[128:131], v[96:103], v6
    s_waitcnt vmcnt(7)
    v_exp_f32 v106, v106
    v_exp_f32 v107, v107
    v_exp_f32 v108, v108
    v_mfma_f32_32x32x16_bf16 v[88:103], v[132:135], v[8:11], 0
    v_exp_f32 v109, v109
    v_exp_f32 v110, v110
    v_exp_f32 v111, v111
    v_exp_f32 v112, v112
    v_exp_f32 v113, v113
    v_exp_f32 v114, v114
    v_exp_f32 v115, v115
    v_smfmac_f32_32x32x32_bf16 v[72:87], v[124:127], v[104:111], v6
    buffer_load_dwordx4 v[124:127], v5, s[64:67], s69 offen offset:1024 sc1
    v_exp_f32 v116, v116
    v_exp_f32 v117, v117
    v_exp_f32 v118, v118
    v_exp_f32 v119, v119
    v_exp_f32 v88, v88
    v_exp_f32 v89, v89
    v_smfmac_f32_32x32x32_bf16 v[72:87], v[128:131], v[112:119], v6
    buffer_load_dwordx4 v[128:131], v5, s[64:67], s69 offen offset:1792 sc1
    v_exp_f32 v90, v90
    v_exp_f32 v91, v91
    v_exp_f32 v92, v92
    v_mfma_f32_32x32x16_bf16 v[104:119], v[132:135], v[12:15], 0
    v_exp_f32 v93, v93
    v_exp_f32 v94, v94
    v_exp_f32 v95, v95
    v_exp_f32 v96, v96
    v_exp_f32 v97, v97
    v_exp_f32 v98, v98
    v_exp_f32 v99, v99
    v_smfmac_f32_32x32x32_bf16 v[24:39], v[136:139], v[88:95], v6
    v_exp_f32 v100, v100
    v_exp_f32 v101, v101
    v_exp_f32 v102, v102
    v_exp_f32 v103, v103
    v_exp_f32 v104, v104
    v_exp_f32 v105, v105
    v_smfmac_f32_32x32x32_bf16 v[24:39], v[140:143], v[96:103], v6
    s_add_u32 s15, s15, 1
    s_and_b32 s15, s15, 15
    s_mul_i32 s69, s15, 2816
    s_cmp_eq_u32 s68, 1
    s_cselect_b32 s69, 2146435072, s69
    v_exp_f32 v106, v106
    v_exp_f32 v107, v107
    v_exp_f32 v108, v108
    v_mfma_f32_32x32x16_bf16 v[88:103], v[132:135], v[16:19], 0
    v_exp_f32 v109, v109
    v_exp_f32 v110, v110
    v_exp_f32 v111, v111
    v_exp_f32 v112, v112
    v_exp_f32 v113, v113
    v_exp_f32 v114, v114
    v_exp_f32 v115, v115
    v_smfmac_f32_32x32x32_bf16 v[40:55], v[136:139], v[104:111], v6
    v_exp_f32 v116, v116
    v_exp_f32 v117, v117
    v_exp_f32 v118, v118
    v_exp_f32 v119, v119
    v_exp_f32 v88, v88
    v_exp_f32 v89, v89
    v_smfmac_f32_32x32x32_bf16 v[40:55], v[140:143], v[112:119], v6
    v_exp_f32 v90, v90
    v_exp_f32 v91, v91
    v_exp_f32 v92, v92
    v_mfma_f32_32x32x16_bf16 v[104:119], v[132:135], v[20:23], 0
    buffer_load_dwordx4 v[132:135], v4, s[64:67], s69 offen offset:0 sc1
    v_exp_f32 v93, v93
    v_exp_f32 v94, v94
    v_exp_f32 v95, v95
    v_exp_f32 v96, v96
    v_exp_f32 v97, v97
    v_exp_f32 v98, v98
    v_exp_f32 v99, v99
    v_smfmac_f32_32x32x32_bf16 v[56:71], v[136:139], v[88:95], v6
    v_exp_f32 v100, v100
    v_exp_f32 v101, v101
    v_exp_f32 v102, v102
    v_exp_f32 v103, v103
    v_exp_f32 v104, v104
    v_exp_f32 v105, v105
    v_smfmac_f32_32x32x32_bf16 v[56:71], v[140:143], v[96:103], v6
    s_waitcnt vmcnt(7)
    v_exp_f32 v106, v106
    v_exp_f32 v107, v107
    v_exp_f32 v108, v108
    v_mfma_f32_32x32x16_bf16 v[88:103], v[144:147], v[8:11], 0
    v_exp_f32 v109, v109
    v_exp_f32 v110, v110
    v_exp_f32 v111, v111
    v_exp_f32 v112, v112
    v_exp_f32 v113, v113
    v_exp_f32 v114, v114
    v_exp_f32 v115, v115
    v_smfmac_f32_32x32x32_bf16 v[72:87], v[136:139], v[104:111], v6
    buffer_load_dwordx4 v[136:139], v5, s[64:67], s69 offen offset:1024 sc1
    v_exp_f32 v116, v116
    v_exp_f32 v117, v117
    v_exp_f32 v118, v118
    v_exp_f32 v119, v119
    v_exp_f32 v88, v88
    v_exp_f32 v89, v89
    v_smfmac_f32_32x32x32_bf16 v[72:87], v[140:143], v[112:119], v6
    buffer_load_dwordx4 v[140:143], v5, s[64:67], s69 offen offset:1792 sc1
    v_exp_f32 v90, v90
    v_exp_f32 v91, v91
    v_exp_f32 v92, v92
    v_mfma_f32_32x32x16_bf16 v[104:119], v[144:147], v[12:15], 0
    v_exp_f32 v93, v93
    v_exp_f32 v94, v94
    v_exp_f32 v95, v95
    v_exp_f32 v96, v96
    v_exp_f32 v97, v97
    v_exp_f32 v98, v98
    v_exp_f32 v99, v99
    v_smfmac_f32_32x32x32_bf16 v[24:39], v[148:151], v[88:95], v6
    v_exp_f32 v100, v100
    v_exp_f32 v101, v101
    v_exp_f32 v102, v102
    v_exp_f32 v103, v103
    v_exp_f32 v104, v104
    v_exp_f32 v105, v105
    v_smfmac_f32_32x32x32_bf16 v[24:39], v[152:155], v[96:103], v6
    s_add_u32 s15, s15, 1
    s_and_b32 s15, s15, 15
    s_mul_i32 s69, s15, 2816
    s_cmp_eq_u32 s68, 1
    s_cselect_b32 s69, 2146435072, s69
    v_exp_f32 v106, v106
    v_exp_f32 v107, v107
    v_exp_f32 v108, v108
    v_mfma_f32_32x32x16_bf16 v[88:103], v[144:147], v[16:19], 0
    v_exp_f32 v109, v109
    v_exp_f32 v110, v110
    v_exp_f32 v111, v111
    v_exp_f32 v112, v112
    v_exp_f32 v113, v113
    v_exp_f32 v114, v114
    v_exp_f32 v115, v115
    v_smfmac_f32_32x32x32_bf16 v[40:55], v[148:151], v[104:111], v6
    v_exp_f32 v116, v116
    v_exp_f32 v117, v117
    v_exp_f32 v118, v118
    v_exp_f32 v119, v119
    v_exp_f32 v88, v88
    v_exp_f32 v89, v89
    v_smfmac_f32_32x32x32_bf16 v[40:55], v[152:155], v[112:119], v6
    s_lshr_b32 s35, s35, 1
    s_bitcmp1_b32 s35, 0
    s_cbranch_scc0 Lp_23
    s_setprio 0
    s_cmp_eq_u32 s14, 0
    s_cbranch_scc0 Lp_23
    s_setprio 1
Lp_23:
    v_exp_f32 v90, v90
    v_exp_f32 v91, v91
    v_exp_f32 v92, v92
    v_mfma_f32_32x32x16_bf16 v[104:119], v[144:147], v[20:23], 0
    buffer_load_dwordx4 v[144:147], v4, s[64:67], s69 offen offset:0 sc1
    v_exp_f32 v93, v93
    v_exp_f32 v94, v94
    v_exp_f32 v95, v95
    v_exp_f32 v96, v96
    v_exp_f32 v97, v97
    v_exp_f32 v98, v98
    v_exp_f32 v99, v99
    v_smfmac_f32_32x32x32_bf16 v[56:71], v[148:151], v[88:95], v6
    v_exp_f32 v100, v100
    v_exp_f32 v101, v101
    v_exp_f32 v102, v102
    v_exp_f32 v103, v103
    v_exp_f32 v104, v104
    v_exp_f32 v105, v105
    v_smfmac_f32_32x32x32_bf16 v[56:71], v[152:155], v[96:103], v6
    s_waitcnt vmcnt(7)
    v_exp_f32 v106, v106
    v_exp_f32 v107, v107
    v_exp_f32 v108, v108
    v_mfma_f32_32x32x16_bf16 v[88:103], v[156:159], v[8:11], 0
    v_exp_f32 v109, v109
    v_exp_f32 v110, v110
    v_exp_f32 v111, v111
    v_exp_f32 v112, v112
    v_exp_f32 v113, v113
    v_exp_f32 v114, v114
    v_exp_f32 v115, v115
    v_smfmac_f32_32x32x32_bf16 v[72:87], v[148:151], v[104:111], v6
    buffer_load_dwordx4 v[148:151], v5, s[64:67], s69 offen offset:1024 sc1
    v_exp_f32 v116, v116
    v_exp_f32 v117, v117
    v_exp_f32 v118, v118
    v_exp_f32 v119, v119
    v_exp_f32 v88, v88
    v_exp_f32 v89, v89
    v_smfmac_f32_32x32x32_bf16 v[72:87], v[152:155], v[112:119], v6
    buffer_load_dwordx4 v[152:155], v5, s[64:67], s69 offen offset:1792 sc1
    v_exp_f32 v90, v90
    v_exp_f32 v91, v91
    v_exp_f32 v92, v92
    v_mfma_f32_32x32x16_bf16 v[104:119], v[156:159], v[12:15], 0
    v_exp_f32 v93, v93
    v_exp_f32 v94, v94
    v_exp_f32 v95, v95
    v_exp_f32 v96, v96
    v_exp_f32 v97, v97
    v_exp_f32 v98, v98
    v_exp_f32 v99, v99
    v_smfmac_f32_32x32x32_bf16 v[24:39], v[160:163], v[88:95], v6
    v_exp_f32 v100, v100
    v_exp_f32 v101, v101
    v_exp_f32 v102, v102
    v_exp_f32 v103, v103
    v_exp_f32 v104, v104
    v_exp_f32 v105, v105
    v_smfmac_f32_32x32x32_bf16 v[24:39], v[164:167], v[96:103], v6
    s_add_u32 s15, s15, 1
    s_and_b32 s15, s15, 15
    s_mul_i32 s69, s15, 2816
    s_cmp_eq_u32 s68, 1
    s_cselect_b32 s69, 2146435072, s69
    v_exp_f32 v106, v106
    v_exp_f32 v107, v107
    v_exp_f32 v108, v108
    v_mfma_f32_32x32x16_bf16 v[88:103], v[156:159], v[16:19], 0
    v_exp_f32 v109, v109
    v_exp_f32 v110, v110
    v_exp_f32 v111, v111
    v_exp_f32 v112, v112
    v_exp_f32 v113, v113
    v_exp_f32 v114, v114
    v_exp_f32 v115, v115
    v_smfmac_f32_32x32x32_bf16 v[40:55], v[160:163], v[104:111], v6
    v_exp_f32 v116, v116
    v_exp_f32 v117, v117
    v_exp_f32 v118, v118
    v_exp_f32 v119, v119
    v_exp_f32 v88, v88
    v_exp_f32 v89, v89
    v_smfmac_f32_32x32x32_bf16 v[40:55], v[164:167], v[112:119], v6
    v_exp_f32 v90, v90
    v_exp_f32 v91, v91
    v_exp_f32 v92, v92
    v_mfma_f32_32x32x16_bf16 v[104:119], v[156:159], v[20:23], 0
    buffer_load_dwordx4 v[156:159], v4, s[64:67], s69 offen offset:0 sc1
    v_exp_f32 v93, v93
    v_exp_f32 v94, v94
    v_exp_f32 v95, v95
    v_exp_f32 v96, v96
    v_exp_f32 v97, v97
    v_exp_f32 v98, v98
    v_exp_f32 v99, v99
    v_smfmac_f32_32x32x32_bf16 v[56:71], v[160:163], v[88:95], v6
    ds_read_b32 v3, v7
    v_exp_f32 v100, v100
    v_exp_f32 v101, v101
    v_exp_f32 v102, v102
    v_exp_f32 v103, v103
    v_exp_f32 v104, v104
    v_exp_f32 v105, v105
    v_smfmac_f32_32x32x32_bf16 v[56:71], v[164:167], v[96:103], v6
    s_waitcnt vmcnt(7)
    v_exp_f32 v106, v106
    v_exp_f32 v107, v107
    v_exp_f32 v108, v108
    v_mfma_f32_32x32x16_bf16 v[88:103], v[120:123], v[8:11], 0
    v_exp_f32 v109, v109
    v_exp_f32 v110, v110
    v_exp_f32 v111, v111
    v_exp_f32 v112, v112
    v_exp_f32 v113, v113
    v_exp_f32 v114, v114
    v_exp_f32 v115, v115
    v_smfmac_f32_32x32x32_bf16 v[72:87], v[160:163], v[104:111], v6
    buffer_load_dwordx4 v[160:163], v5, s[64:67], s69 offen offset:1024 sc1
    s_sub_u32 s68, s68, 1
    s_cmp_lg_u32 s68, 0
    v_exp_f32 v116, v116
    v_exp_f32 v117, v117
    v_exp_f32 v118, v118
    v_exp_f32 v119, v119
    s_cbranch_scc1 L_att
    s_nop 1
    v_smfmac_f32_32x32x32_bf16 v[72:87], v[164:167], v[112:119], v6
    v_mov_b32 v13, s34
    v_lshlrev_b32 v14, 4, v0
    v_lshlrev_b32 v15, 2, v0
    s_waitcnt lgkmcnt(0)
    v_readfirstlane_b32 s8, v3
    v_add_u32 v16, s29, v14
    v_add_u32 v17, s29, v15
    s_nop 0
    s_cmp_ge_u32 s8, 4
    s_cbranch_scc1 L_pfree
Lw_24:
    ds_read_b32 v3, v7 offset:0
    s_waitcnt lgkmcnt(0)
    v_readfirstlane_b32 s8, v3
    s_nop 2
    s_cmp_ge_u32 s8, 4
    s_cbranch_scc1 Ld_25
    s_sleep 1
    s_sub_u32 s51, s51, 1
    s_cbranch_scc0 Lw_24
    s_mov_b32 s51, 0
Ld_25:
L_pfree:
    ds_write_b128 v16, v[40:43] offset:0
    ds_write_b128 v16, v[44:47] offset:1024
    ds_write_b32 v17, v48 offset:2048
    v_add_u32 v18, s30, v14
    v_add_u32 v19, s30, v15
    ds_write_b128 v18, v[56:59] offset:2304
    ds_write_b128 v18, v[60:63] offset:3328
    ds_write_b32 v19, v64 offset:4352
    v_add_u32 v16, s31, v14
    v_add_u32 v17, s31, v15
    ds_write_b128 v16, v[72:75] offset:4608
    ds_write_b128 v16, v[76:79] offset:5632
    ds_write_b32 v17, v80 offset:6656
    v_add_u32 v18, s28, v14
    v_add_u32 v19, s28, v15
    s_waitcnt lgkmcnt(0)
    s_mov_b64 exec, 1
    ds_add_rtn_u32 v3, v13, v2 offset:0
    s_mov_b64 exec, -1
    s_waitcnt lgkmcnt(0)
    v_readfirstlane_b32 s8, v3
    s_nop 2
    s_cmp_eq_u32 s8, 3
    s_cbranch_scc1 Ls_26
Lw_27:
    ds_read_b32 v3, v13 offset:0
    s_waitcnt lgkmcnt(0)
    v_readfirstlane_b32 s8, v3
    s_nop 2
    s_cmp_ge_u32 s8, 4
    s_cbranch_scc1 Ld_28
    s_sub_u32 s51, s51, 1
    s_cbranch_scc0 Lw_27
    s_mov_b32 s51, 0
Ld_28:
Ls_26:
    ds_read_b128 v[40:43], v18 offset:0
    ds_read_b128 v[44:47], v18 offset:1024
    ds_read_b32 v48, v19 offset:2048
    ds_read_b128 v[56:59], v18 offset:2304
    ds_read_b128 v[60:63], v18 offset:3328
    ds_read_b32 v64, v19 offset:4352
    ds_read_b128 v[72:75], v18 offset:4608
    ds_read_b128 v[76:79], v18 offset:5632
    ds_read_b32 v80, v19 offset:6656
    s_mov_b32 s13, s32
    s_waitcnt vmcnt(0)
    v_mov_b32 v146, v14
    s_waitcnt lgkmcnt(6)
    v_pk_add_f32 v[24:25], v[24:25], v[40:41]
    v_pk_add_f32 v[26:27], v[26:27], v[42:43]
    v_pk_add_f32 v[28:29], v[28:29], v[44:45]
    v_pk_add_f32 v[30:31], v[30:31], v[46:47]
    v_add_f32 v32, v32, v48
    s_waitcnt lgkmcnt(3)
    v_pk_add_f32 v[24:25], v[24:25], v[56:57]
    v_pk_add_f32 v[26:27], v[26:27], v[58:59]
    v_pk_add_f32 v[28:29], v[28:29], v[60:61]
    v_pk_add_f32 v[30:31], v[30:31], v[62:63]
    v_add_f32 v32, v32, v64
    s_waitcnt lgkmcnt(0)
    v_pk_add_f32 v[24:25], v[24:25], v[72:73]
    v_pk_add_f32 v[26:27], v[26:27], v[74:75]
    v_pk_add_f32 v[28:29], v[28:29], v[76:77]
    v_pk_add_f32 v[30:31], v[30:31], v[78:79]
    v_add_f32 v32, v32, v80
    v_pk_add_f32 v[150:151], v[24:25], v[26:27]
    v_pk_add_f32 v[152:153], v[28:29], v[30:31]
    v_pk_add_f32 v[150:151], v[150:151], v[152:153]
    v_add_f32 v150, v150, v151
    v_fma_f32 v150, v150, 0, v32
    v_subrev_u32 v150, 0x21800000, v150
    v_cmp_ge_u32 vcc, 0x3c000000, v150
    s_nop 2
    s_cmp_eq_u64 vcc, exec
    s_cbranch_scc0 L_fallback
L_att_fin:
    v_rcp_f32 v150, v32
    s_nop 0
    v_pk_mul_f32 v[24:25], v[24:25], v[150:151] op_sel_hi:[1,0]
    v_pk_mul_f32 v[26:27], v[26:27], v[150:151] op_sel_hi:[1,0]
    v_pk_mul_f32 v[28:29], v[28:29], v[150:151] op_sel_hi:[1,0]
    v_pk_mul_f32 v[30:31], v[30:31], v[150:151] op_sel_hi:[1,0]
    v_cvt_pk_bf16_f32 v152, v24, v25
    v_cvt_pk_bf16_f32 v153, v26, v27
    v_cvt_pk_bf16_f32 v154, v28, v29
    v_cvt_pk_bf16_f32 v155, v30, v31
    v_min_u32 v152, -2, v152
    v_min_u32 v153, -2, v153
    v_min_u32 v154, -2, v154
    v_min_u32 v155, -2, v155
    s_lshl_b32 s10, s14, 2
    v_add_u32 v151, s10, v1
    buffer_store_dwordx4 v[152:155], v146, s[64:67], s13 offen sc1
    s_waitcnt vmcnt(0)
    s_mov_b64 exec, 1
    ds_add_u32 v151, v2 offset:64
    s_mov_b64 exec, -1
    s_or_b32 s10, s2, s7
    s_or_b32 s10, s10, s14
    s_cmp_eq_u32 s10, 0
    s_cbranch_scc0 L_end
    v_mov_b32 v150, s50
    v_mov_b32 v151, 0
    s_mov_b64 exec, 1
    buffer_store_dword v150, v151, s[64:67], 0 offen sc1
    s_mov_b64 exec, -1
    s_branch L_end
L_fallback:
    s_mul_i32 s10, s7, 45056
    v_subrev_u32 v7, s10, v4
    v_subrev_u32 v151, s10, v5
    v_mov_b32 v150, 0xff800000
    s_mov_b32 s69, 0
L_fb1:
    buffer_load_dwordx4 v[120:123], v7, s[64:67], s69 offen sc1
    s_waitcnt vmcnt(0)
    v_mfma_f32_32x32x16_bf16 v[88:103], v[120:123], v[8:11], 0
    s_nop 11
    v_max3_f32 v150, v150, v88, v89
    v_max3_f32 v150, v150, v90, v91
    v_max3_f32 v150, v150, v92, v93
    v_max3_f32 v150, v150, v94, v95
    v_max3_f32 v150, v150, v96, v97
    v_max3_f32 v150, v150, v98, v99
    v_max3_f32 v150, v150, v100, v101
    v_max3_f32 v150, v150, v102, v103
    s_add_u32 s69, s69, 2816
    s_cmp_lt_u32 s69, 180224
    s_cbranch_scc1 L_fb1
    v_mov_b32 v152, v150
    s_nop 1
    v_permlane32_swap_b32 v150, v152
    v_max_f32 v150, v150, v152
    v_sub_f32 v40, 0, v150
    v_sub_f32 v41, 0, v150
    v_sub_f32 v42, 0, v150
    v_sub_f32 v43, 0, v150
    v_sub_f32 v44, 0, v150
    v_sub_f32 v45, 0, v150
    v_sub_f32 v46, 0, v150
    v_sub_f32 v47, 0, v150
    v_sub_f32 v48, 0, v150
    v_sub_f32 v49, 0, v150
    v_sub_f32 v50, 0, v150
    v_sub_f32 v51, 0, v150
    v_sub_f32 v52, 0, v150
    v_sub_f32 v53, 0, v150
    v_sub_f32 v54, 0, v150
    v_sub_f32 v55, 0, v150
    v_mov_b32 v24, 0
    v_mov_b32 v25, 0
    v_mov_b32 v26, 0
    v_mov_b32 v27, 0
    v_mov_b32 v28, 0
    v_mov_b32 v29, 0
    v_mov_b32 v30, 0
    v_mov_b32 v31, 0
    v_mov_b32 v32, 0
    v_mov_b32 v33, 0
    v_mov_b32 v34, 0
    v_mov_b32 v35, 0
    v_mov_b32 v36, 0
    v_mov_b32 v37, 0
    v_mov_b32 v38, 0
    v_mov_b32 v39, 0
    s_mov_b32 s69, 0
L_fb2:
    buffer_load_dwordx4 v[120:123], v7, s[64:67], s69 offen sc1
    buffer_load_dwordx4 v[124:127], v151, s[64:67], s69 offen offset:1024 sc1
    buffer_load_dwordx4 v[128:131], v151, s[64:67], s69 offen offset:1792 sc1
    s_waitcnt vmcnt(0)
    v_mfma_f32_32x32x16_bf16 v[88:103], v[120:123], v[8:11], v[40:55]
    s_nop 11
    v_exp_f32 v88, v88
    v_exp_f32 v89, v89
    v_exp_f32 v90, v90
    v_exp_f32 v91, v91
    v_exp_f32 v92, v92
    v_exp_f32 v93, v93
    v_exp_f32 v94, v94
    v_exp_f32 v95, v95
    v_exp_f32 v96, v96
    v_exp_f32 v97, v97
    v_exp_f32 v98, v98
    v_exp_f32 v99, v99
    v_exp_f32 v100, v100
    v_exp_f32 v101, v101
    v_exp_f32 v102, v102
    v_exp_f32 v103, v103
    v_smfmac_f32_32x32x32_bf16 v[24:39], v[124:127], v[88:95], v6
    s_nop 0
    v_smfmac_f32_32x32x32_bf16 v[24:39], v[128:131], v[96:103], v6
    s_add_u32 s69, s69, 2816
    s_cmp_lt_u32 s69, 180224
    s_nop 9
    s_cbranch_scc1 L_fb2
    s_nop 3
    s_branch L_att_fin
L_first:
    s_cmp_eq_u32 s14, 0
    s_cbranch_scc0 L_first_ld
L_fp:
    s_waitcnt vmcnt(0)
    v_cmp_ne_u32 vcc, s50, v145
    s_nop 2
    s_and_b64 exec, exec, vcc
    s_cbranch_execz L_fp_ok
    buffer_load_dword v145, v144, s[64:67], s40 offen sc1
    s_sub_u32 s51, s51, 1
    s_cbranch_scc0 L_fp
    s_mov_b32 s51, 0
    s_waitcnt vmcnt(0)
L_fp_ok:
    s_mov_b64 exec, -1
    s_mov_b64 exec, 1
    ds_add_u32 v1, v2 offset:24
    s_mov_b64 exec, -1
L_first_ld:
    buffer_load_dwordx4 v[144:147], v4, s[64:67], s38 offen offset:0 sc1
    buffer_load_dwordx4 v[148:151], v5, s[64:67], s38 offen offset:1024 sc1
    buffer_load_dwordx4 v[152:155], v5, s[64:67], s38 offen offset:1792 sc1
    buffer_load_dwordx4 v[156:159], v4, s[64:67], s39 offen offset:0 sc1
    buffer_load_dwordx4 v[160:163], v5, s[64:67], s39 offen offset:1024 sc1
    buffer_load_dwordx4 v[164:167], v5, s[64:67], s39 offen offset:1792 sc1
    s_branch L_first_ret
L_role_s:
    s_setprio 2
    s_and_b32 s68, s7, 1
    s_lshr_b32 s69, s7, 1
    s_lshl_b32 s8, s6, 2
    s_lshl_b32 s9, s6, 9
    s_lshl_b32 s10, s68, 8
    s_add_u32 s9, s9, s10
    s_lshl_b32 s10, s69, 7
    s_add_u32 s9, s9, s10
    v_lshlrev_b32 v4, 1, v0
    s_mov_b32 s54, 131072
    s_waitcnt lgkmcnt(0)
    s_mov_b32 s64, s48
    s_mov_b32 s65, s49
    s_load_dword s12, s[40:41], s8
    s_load_dword s13, s[42:43], s8
    s_mov_b32 s52, s28
    s_mov_b32 s53, s29
    buffer_load_ushort v8, v4, s[52:55], s9 offen
    s_mov_b32 s52, s30
    s_mov_b32 s53, s31
    buffer_load_ushort v9, v4, s[52:55], s9 offen
    s_mov_b32 s52, s32
    s_mov_b32 s53, s33
    buffer_load_ushort v10, v4, s[52:55], s9 offen
    s_mov_b32 s52, s34
    s_mov_b32 s53, s35
    buffer_load_ushort v11, v4, s[52:55], s9 offen
    s_mov_b32 s52, s36
    s_mov_b32 s53, s37
    buffer_load_ushort v12, v4, s[52:55], s9 offen
    s_mov_b32 s52, s38
    s_mov_b32 s53, s39
    buffer_load_ushort v13, v4, s[52:55], s9 offen
    s_barrier
    s_mul_i32 s46, s68, 13824
    s_add_u32 s46, s46, 256
    v_and_b32 v16, 7, v0
    v_lshrrev_b32 v17, 5, v0
    v_lshrrev_b32 v18, 3, v0
    v_and_b32 v19, 3, v18
    v_mul_u32_u24 v19, 144, v19
    v_lshl_add_u32 v19, v16, 4, v19
    v_add_u32 v19, s46, v19
    v_lshlrev_b32 v20, 3, v17
    v_sub_u32 v146, v19, v20
    v_mul_u32_u24 v20, 576, v17
    v_add_u32 v147, v19, v20
    v_mul_u32_u24 v19, 144, v18
    v_lshl_add_u32 v19, v16, 4, v19
    v_add_u32 v148, s46, v19
    v_cmp_eq_u32 s[10:11], 0, v16
    v_mov_b32 v19, 16
    s_nop 0
    v_cndmask_b32 v19, v19, 32, s[10:11]
    v_sub_u32 v149, v148, v19
    s_mul_i32 s10, s69, 1152
    s_sub_u32 s11, s46, s10
    v_and_b32 v19, 15, v0
    v_mul_u32_u24 v19, 144, v19
    v_bfe_u32 v21, v0, 4, 1
    v_mul_u32_u24 v22, 6912, v21
    v_add_u32 v19, v19, v22
    v_lshlrev_b32 v22, 4, v17
    v_sub_u32 v19, v19, v22
    v_add_u32 v156, s11, v19
    s_mul_i32 s10, s68, 17664
    s_lshl_b32 s11, s69, 10
    s_add_u32 s10, s10, s11
    s_add_u32 s10, s10, 65536
    v_and_b32 v19, 3, v0
    v_mul_u32_u24 v19, 4416, v19
    v_bfe_u32 v23, v0, 2, 3
    v_lshl_add_u32 v19, v23, 4, v19
    v_add_u32 v19, v19, v22
    v_add_u32 v157, s10, v19
    s_lshl_b32 s10, s7, 10
    s_add_u32 s10, s10, 65536
    v_lshl_add_u32 v166, v0, 4, s10
    v_and_b32 v19, 31, v0
    v_lshlrev_b32 v23, 3, v19
    v_lshl_add_u32 v162, v17, 10, v23
    v_and_b32 v23, 2, v18
    v_lshlrev_b32 v23, 1, v23
    v_xor_b32 v23, v16, v23
    v_lshlrev_b32 v24, 10, v18
    v_lshl_add_u32 v161, v23, 4, v24
    v_bfe_u32 v23, v0, 2, 2
    v_lshl_add_u32 v24, v17, 3, v23
    v_lshlrev_b32 v24, 7, v24
    v_and_b32 v23, 2, v23
    v_lshl_add_u32 v24, v23, 5, v24
    v_lshl_add_u32 v24, v21, 5, v24
    v_and_b32 v25, 1, v0
    v_lshl_add_u32 v24, v25, 4, v24
    v_bfe_u32 v23, v0, 1, 1
    v_lshl_add_u32 v24, v23, 3, v24
    s_lshl_b32 s10, s7, 13
    s_add_u32 s10, s10, 32768
    v_add_u32 v160, s10, v24
    v_lshl_add_u32 v19, v19, 4, v20
    s_mul_i32 s10, s7, 2304
    s_add_u32 s10, s10, 65536
    v_add_u32 v163, s10, v19
    v_lshlrev_b32 v19, 4, v18
    v_mul_u32_u24 v23, 576, v25
    v_add_u32 v19, v19, v23
    v_bfe_u32 v23, v0, 1, 2
    v_mul_u32_u24 v23, 9344, v23
    v_add_u32 v19, v19, v23
    s_lshl_b32 s10, s7, 7
    s_add_u32 s10, s10, 65536
    v_add_u32 v164, s10, v19
    v_lshlrev_b32 v19, 11, v18
    v_lshl_add_u32 v165, v16, 4, v19
    s_lshl_b32 s10, s7, 12
    s_add_u32 s10, s10, 131072
    v_bfe_u32 v5, v0, 1, 2
    v_lshlrev_b32 v5, 4, v5
    v_lshl_add_u32 v5, v0, 6, v5
    v_add_u32 v150, s10, v5
    v_xor_b32 v151, 16, v150
    v_xor_b32 v152, 32, v150
    v_xor_b32 v153, 48, v150
    v_bfe_u32 v5, v0, 2, 2
    v_lshrrev_b32 v6, 5, v0
    v_lshl_add_u32 v6, v6, 3, v5
    v_lshlrev_b32 v6, 6, v6
    v_bfe_u32 v7, v0, 4, 1
    v_lshlrev_b32 v7, 1, v7
    v_bfe_u32 v14, v0, 1, 1
    v_add_u32 v7, v7, v14
    v_lshrrev_b32 v5, 1, v5
    v_xor_b32 v7, v7, v5
    v_lshl_add_u32 v6, v7, 4, v6
    v_and_b32 v7, 1, v0
    v_lshl_add_u32 v6, v7, 3, v6
    v_add_u32 v154, s10, v6
    v_xor_b32 v155, 32, v154
    s_waitcnt lgkmcnt(0)
    s_lshl_b32 s10, s68, 4
    s_lshr_b32 s12, s12, s10
    s_lshl_b32 s12, s12, 16
    s_lshr_b32 s13, s13, s10
    s_lshl_b32 s13, s13, 16
    v_mov_b32 v14, 0x3fb8aa3b
    v_mul_f32 v15, s12, v14
    v_exp_f32 v15, v15
    s_nop 0
    v_cvt_pk_bf16_f32 v15, v15, v15
    v_and_b32 v15, 0xffff0000, v15
    s_waitcnt vmcnt(0)
    v_lshlrev_b32 v8, 16, v8
    v_lshlrev_b32 v9, 16, v9
    v_lshlrev_b32 v10, 16, v10
    v_lshlrev_b32 v11, 16, v11
    v_lshlrev_b32 v12, 16, v12
    v_lshlrev_b32 v13, 16, v13
    v_mul_f32 v8, v15, v8
    v_mul_f32 v9, v15, v9
    v_mul_f32 v10, v15, v10
    v_mul_f32 v11, v15, v11
    v_mul_f32 v8, v14, v8
    v_mul_f32 v9, 0.15915494, v9
    v_pk_mul_f32 v[28:29], v[10:11], v[12:13] op_sel_hi:[1,0]
    v_pk_fma_f32 v[16:17], v[10:11], v[12:13], v[28:29] op_sel:[1,1,0] op_sel_hi:[0,1,1] neg_lo:[0,1,0]
    v_exp_f32 v28, v8
    v_rndne_f32 v29, v9
    v_sub_f32 v29, v9, v29
    v_cos_f32 v18, v29
    v_sin_f32 v19, v29
    v_mul_f32 v18, v28, v18
    v_mul_f32 v19, v28, v19
    v_mul_f32 v30, 0x43800000, v8
    v_mul_f32 v31, 0x43800000, v9
    v_exp_f32 v28, v30
    v_rndne_f32 v29, v31
    v_sub_f32 v29, v31, v29
    v_cos_f32 v26, v29
    v_sin_f32 v27, v29
    v_mul_f32 v26, v28, v26
    v_mul_f32 v27, v28, v27
    v_pk_mul_f32 v[28:29], v[18:19], v[18:19] op_sel_hi:[1,0]
    v_pk_fma_f32 v[20:21], v[18:19], v[18:19], v[28:29] op_sel:[1,1,0] op_sel_hi:[0,1,1] neg_lo:[0,1,0]
    v_pk_mul_f32 v[28:29], v[20:21], v[20:21] op_sel_hi:[1,0]
    v_pk_fma_f32 v[22:23], v[20:21], v[20:21], v[28:29] op_sel:[1,1,0] op_sel_hi:[0,1,1] neg_lo:[0,1,0]
    v_pk_mul_f32 v[28:29], v[22:23], v[22:23] op_sel_hi:[1,0]
    v_pk_fma_f32 v[24:25], v[22:23], v[22:23], v[28:29] op_sel:[1,1,0] op_sel_hi:[0,1,1] neg_lo:[0,1,0]
    v_mov_b32 v128, 1.0
    v_mov_b32 v129, 0
    v_pk_mul_f32 v[28:29], v[128:129], v[24:25] op_sel_hi:[1,0]
    v_pk_fma_f32 v[130:131], v[128:129], v[24:25], v[28:29] op_sel:[1,1,0] op_sel_hi:[0,1,1] neg_lo:[0,1,0]
    v_cvt_pk_bf16_f32 v32, v128, v130
    v_cvt_pk_bf16_f32 v48, -v129, -v131
    v_pk_mul_f32 v[28:29], v[130:131], v[24:25] op_sel_hi:[1,0]
    v_pk_fma_f32 v[128:129], v[130:131], v[24:25], v[28:29] op_sel:[1,1,0] op_sel_hi:[0,1,1] neg_lo:[0,1,0]
    v_pk_mul_f32 v[28:29], v[128:129], v[24:25] op_sel_hi:[1,0]
    v_pk_fma_f32 v[130:131], v[128:129], v[24:25], v[28:29] op_sel:[1,1,0] op_sel_hi:[0,1,1] neg_lo:[0,1,0]
    v_cvt_pk_bf16_f32 v33, v128, v130
    v_cvt_pk_bf16_f32 v49, -v129, -v131
    v_pk_mul_f32 v[28:29], v[130:131], v[24:25] op_sel_hi:[1,0]
    v_pk_fma_f32 v[128:129], v[130:131], v[24:25], v[28:29] op_sel:[1,1,0] op_sel_hi:[0,1,1] neg_lo:[0,1,0]
    v_pk_mul_f32 v[28:29], v[128:129], v[24:25] op_sel_hi:[1,0]
    v_pk_fma_f32 v[130:131], v[128:129], v[24:25], v[28:29] op_sel:[1,1,0] op_sel_hi:[0,1,1] neg_lo:[0,1,0]
    v_cvt_pk_bf16_f32 v34, v128, v130
    v_cvt_pk_bf16_f32 v50, -v129, -v131
    v_pk_mul_f32 v[28:29], v[130:131], v[24:25] op_sel_hi:[1,0]
    v_pk_fma_f32 v[128:129], v[130:131], v[24:25], v[28:29] op_sel:[1,1,0] op_sel_hi:[0,1,1] neg_lo:[0,1,0]
    v_pk_mul_f32 v[28:29], v[128:129], v[24:25] op_sel_hi:[1,0]
    v_pk_fma_f32 v[130:131], v[128:129], v[24:25], v[28:29] op_sel:[1,1,0] op_sel_hi:[0,1,1] neg_lo:[0,1,0]
    v_cvt_pk_bf16_f32 v35, v128, v130
    v_cvt_pk_bf16_f32 v51, -v129, -v131
    v_pk_mul_f32 v[28:29], v[130:131], v[24:25] op_sel_hi:[1,0]
    v_pk_fma_f32 v[128:129], v[130:131], v[24:25], v[28:29] op_sel:[1,1,0] op_sel_hi:[0,1,1] neg_lo:[0,1,0]
    v_pk_mul_f32 v[28:29], v[128:129], v[24:25] op_sel_hi:[1,0]
    v_pk_fma_f32 v[130:131], v[128:129], v[24:25], v[28:29] op_sel:[1,1,0] op_sel_hi:[0,1,1] neg_lo:[0,1,0]
    v_cvt_pk_bf16_f32 v36, v128, v130
    v_cvt_pk_bf16_f32 v52, -v129, -v131
    v_pk_mul_f32 v[28:29], v[130:131], v[24:25] op_sel_hi:[1,0]
    v_pk_fma_f32 v[128:129], v[130:131], v[24:25], v[28:29] op_sel:[1,1,0] op_sel_hi:[0,1,1] neg_lo:[0,1,0]
    v_pk_mul_f32 v[28:29], v[128:129], v[24:25] op_sel_hi:[1,0]
    v_pk_fma_f32 v[130:131], v[128:129], v[24:25], v[28:29] op_sel:[1,1,0] op_sel_hi:[0,1,1] neg_lo:[0,1,0]
    v_cvt_pk_bf16_f32 v37, v128, v130
    v_cvt_pk_bf16_f32 v53, -v129, -v131
    v_pk_mul_f32 v[28:29], v[130:131], v[24:25] op_sel_hi:[1,0]
    v_pk_fma_f32 v[128:129], v[130:131], v[24:25], v[28:29] op_sel:[1,1,0] op_sel_hi:[0,1,1] neg_lo:[0,1,0]
    v_pk_mul_f32 v[28:29], v[128:129], v[24:25] op_sel_hi:[1,0]
    v_pk_fma_f32 v[130:131], v[128:129], v[24:25], v[28:29] op_sel:[1,1,0] op_sel_hi:[0,1,1] neg_lo:[0,1,0]
    v_cvt_pk_bf16_f32 v38, v128, v130
    v_cvt_pk_bf16_f32 v54, -v129, -v131
    v_pk_mul_f32 v[28:29], v[130:131], v[24:25] op_sel_hi:[1,0]
    v_pk_fma_f32 v[128:129], v[130:131], v[24:25], v[28:29] op_sel:[1,1,0] op_sel_hi:[0,1,1] neg_lo:[0,1,0]
    v_pk_mul_f32 v[28:29], v[128:129], v[24:25] op_sel_hi:[1,0]
    v_pk_fma_f32 v[130:131], v[128:129], v[24:25], v[28:29] op_sel:[1,1,0] op_sel_hi:[0,1,1] neg_lo:[0,1,0]
    v_cvt_pk_bf16_f32 v39, v128, v130
    v_cvt_pk_bf16_f32 v55, -v129, -v131
    v_pk_mul_f32 v[28:29], v[130:131], v[24:25] op_sel_hi:[1,0]
    v_pk_fma_f32 v[128:129], v[130:131], v[24:25], v[28:29] op_sel:[1,1,0] op_sel_hi:[0,1,1] neg_lo:[0,1,0]
    v_pk_mul_f32 v[28:29], v[128:129], v[24:25] op_sel_hi:[1,0]
    v_pk_fma_f32 v[130:131], v[128:129], v[24:25], v[28:29] op_sel:[1,1,0] op_sel_hi:[0,1,1] neg_lo:[0,1,0]
    v_cvt_pk_bf16_f32 v40, v128, v130
    v_cvt_pk_bf16_f32 v56, -v129, -v131
    v_pk_mul_f32 v[28:29], v[130:131], v[24:25] op_sel_hi:[1,0]
    v_pk_fma_f32 v[128:129], v[130:131], v[24:25], v[28:29] op_sel:[1,1,0] op_sel_hi:[0,1,1] neg_lo:[0,1,0]
    v_pk_mul_f32 v[28:29], v[128:129], v[24:25] op_sel_hi:[1,0]
    v_pk_fma_f32 v[130:131], v[128:129], v[24:25], v[28:29] op_sel:[1,1,0] op_sel_hi:[0,1,1] neg_lo:[0,1,0]
    v_cvt_pk_bf16_f32 v41, v128, v130
    v_cvt_pk_bf16_f32 v57, -v129, -v131
    v_pk_mul_f32 v[28:29], v[130:131], v[24:25] op_sel_hi:[1,0]
    v_pk_fma_f32 v[128:129], v[130:131], v[24:25], v[28:29] op_sel:[1,1,0] op_sel_hi:[0,1,1] neg_lo:[0,1,0]
    v_pk_mul_f32 v[28:29], v[128:129], v[24:25] op_sel_hi:[1,0]
    v_pk_fma_f32 v[130:131], v[128:129], v[24:25], v[28:29] op_sel:[1,1,0] op_sel_hi:[0,1,1] neg_lo:[0,1,0]
    v_cvt_pk_bf16_f32 v42, v128, v130
    v_cvt_pk_bf16_f32 v58, -v129, -v131
    v_pk_mul_f32 v[28:29], v[130:131], v[24:25] op_sel_hi:[1,0]
    v_pk_fma_f32 v[128:129], v[130:131], v[24:25], v[28:29] op_sel:[1,1,0] op_sel_hi:[0,1,1] neg_lo:[0,1,0]
    v_pk_mul_f32 v[28:29], v[128:129], v[24:25] op_sel_hi:[1,0]
    v_pk_fma_f32 v[130:131], v[128:129], v[24:25], v[28:29] op_sel:[1,1,0] op_sel_hi:[0,1,1] neg_lo:[0,1,0]
    v_cvt_pk_bf16_f32 v43, v128, v130
    v_cvt_pk_bf16_f32 v59, -v129, -v131
    v_pk_mul_f32 v[28:29], v[130:131], v[24:25] op_sel_hi:[1,0]
    v_pk_fma_f32 v[128:129], v[130:131], v[24:25], v[28:29] op_sel:[1,1,0] op_sel_hi:[0,1,1] neg_lo:[0,1,0]
    v_pk_mul_f32 v[28:29], v[128:129], v[24:25] op_sel_hi:[1,0]
    v_pk_fma_f32 v[130:131], v[128:129], v[24:25], v[28:29] op_sel:[1,1,0] op_sel_hi:[0,1,1] neg_lo:[0,1,0]
    v_cvt_pk_bf16_f32 v44, v128, v130
    v_cvt_pk_bf16_f32 v60, -v129, -v131
    v_pk_mul_f32 v[28:29], v[130:131], v[24:25] op_sel_hi:[1,0]
    v_pk_fma_f32 v[128:129], v[130:131], v[24:25], v[28:29] op_sel:[1,1,0] op_sel_hi:[0,1,1] neg_lo:[0,1,0]
    v_pk_mul_f32 v[28:29], v[128:129], v[24:25] op_sel_hi:[1,0]
    v_pk_fma_f32 v[130:131], v[128:129], v[24:25], v[28:29] op_sel:[1,1,0] op_sel_hi:[0,1,1] neg_lo:[0,1,0]
    v_cvt_pk_bf16_f32 v45, v128, v130
    v_cvt_pk_bf16_f32 v61, -v129, -v131
    v_pk_mul_f32 v[28:29], v[130:131], v[24:25] op_sel_hi:[1,0]
    v_pk_fma_f32 v[128:129], v[130:131], v[24:25], v[28:29] op_sel:[1,1,0] op_sel_hi:[0,1,1] neg_lo:[0,1,0]
    v_pk_mul_f32 v[28:29], v[128:129], v[24:25] op_sel_hi:[1,0]
    v_pk_fma_f32 v[130:131], v[128:129], v[24:25], v[28:29] op_sel:[1,1,0] op_sel_hi:[0,1,1] neg_lo:[0,1,0]
    v_cvt_pk_bf16_f32 v46, v128, v130
    v_cvt_pk_bf16_f32 v62, -v129, -v131
    v_pk_mul_f32 v[28:29], v[130:131], v[24:25] op_sel_hi:[1,0]
    v_pk_fma_f32 v[128:129], v[130:131], v[24:25], v[28:29] op_sel:[1,1,0] op_sel_hi:[0,1,1] neg_lo:[0,1,0]
    v_pk_mul_f32 v[28:29], v[128:129], v[24:25] op_sel_hi:[1,0]
    v_pk_fma_f32 v[130:131], v[128:129], v[24:25], v[28:29] op_sel:[1,1,0] op_sel_hi:[0,1,1] neg_lo:[0,1,0]
    v_cvt_pk_bf16_f32 v47, v128, v130
    v_cvt_pk_bf16_f32 v63, -v129, -v131
    ds_write_b128 v150, v[32:35]
    ds_write_b128 v151, v[36:39]
    ds_write_b128 v152, v[40:43]
    ds_write_b128 v153, v[44:47]
    ds_read_b64_tr_b16 v[64:65], v154 offset:0
    ds_read_b64_tr_b16 v[66:67], v155 offset:256
    ds_read_b64_tr_b16 v[68:69], v154 offset:1024
    ds_read_b64_tr_b16 v[70:71], v155 offset:1280
    ds_read_b64_tr_b16 v[72:73], v154 offset:2048
    ds_read_b64_tr_b16 v[74:75], v155 offset:2304
    ds_read_b64_tr_b16 v[76:77], v154 offset:3072
    ds_read_b64_tr_b16 v[78:79], v155 offset:3328
    ds_write_b128 v150, v[48:51]
    ds_write_b128 v151, v[52:55]
    ds_write_b128 v152, v[56:59]
    ds_write_b128 v153, v[60:63]
    ds_read_b64_tr_b16 v[80:81], v154 offset:0
    ds_read_b64_tr_b16 v[82:83], v155 offset:256
    ds_read_b64_tr_b16 v[84:85], v154 offset:1024
    ds_read_b64_tr_b16 v[86:87], v155 offset:1280
    ds_read_b64_tr_b16 v[88:89], v154 offset:2048
    ds_read_b64_tr_b16 v[90:91], v155 offset:2304
    ds_read_b64_tr_b16 v[92:93], v154 offset:3072
    ds_read_b64_tr_b16 v[94:95], v155 offset:3328
    v_pk_mul_f32 v[28:29], v[16:17], v[26:27] op_sel_hi:[1,0]
    v_pk_fma_f32 v[132:133], v[16:17], v[26:27], v[28:29] op_sel:[1,1,0] op_sel_hi:[0,1,1] neg_lo:[0,1,0]
    v_pk_mul_f32 v[28:29], v[132:133], v[26:27] op_sel_hi:[1,0]
    v_pk_fma_f32 v[134:135], v[132:133], v[26:27], v[28:29] op_sel:[1,1,0] op_sel_hi:[0,1,1] neg_lo:[0,1,0]
    v_pk_mul_f32 v[28:29], v[134:135], v[26:27] op_sel_hi:[1,0]
    v_pk_fma_f32 v[136:137], v[134:135], v[26:27], v[28:29] op_sel:[1,1,0] op_sel_hi:[0,1,1] neg_lo:[0,1,0]
    v_pk_mul_f32 v[28:29], v[136:137], v[26:27] op_sel_hi:[1,0]
    v_pk_fma_f32 v[138:139], v[136:137], v[26:27], v[28:29] op_sel:[1,1,0] op_sel_hi:[0,1,1] neg_lo:[0,1,0]
    v_pk_mul_f32 v[28:29], v[138:139], v[26:27] op_sel_hi:[1,0]
    v_pk_fma_f32 v[140:141], v[138:139], v[26:27], v[28:29] op_sel:[1,1,0] op_sel_hi:[0,1,1] neg_lo:[0,1,0]
    v_pk_mul_f32 v[28:29], v[140:141], v[26:27] op_sel_hi:[1,0]
    v_pk_fma_f32 v[142:143], v[140:141], v[26:27], v[28:29] op_sel:[1,1,0] op_sel_hi:[0,1,1] neg_lo:[0,1,0]
    v_pk_mul_f32 v[28:29], v[142:143], v[26:27] op_sel_hi:[1,0]
    v_pk_fma_f32 v[144:145], v[142:143], v[26:27], v[28:29] op_sel:[1,1,0] op_sel_hi:[0,1,1] neg_lo:[0,1,0]
    s_waitcnt lgkmcnt(8)
    v_pk_mul_f32 v[28:29], v[16:17], v[18:19] op_sel_hi:[1,0]
    v_pk_fma_f32 v[130:131], v[16:17], v[18:19], v[28:29] op_sel:[1,1,0] op_sel_hi:[0,1,1] neg_lo:[0,1,0]
    v_cvt_pk_bf16_f32 v32, v16, v130
    v_cvt_pk_bf16_f32 v48, v17, v131
    v_pk_mul_f32 v[28:29], v[130:131], v[18:19] op_sel_hi:[1,0]
    v_pk_fma_f32 v[128:129], v[130:131], v[18:19], v[28:29] op_sel:[1,1,0] op_sel_hi:[0,1,1] neg_lo:[0,1,0]
    v_pk_mul_f32 v[28:29], v[128:129], v[18:19] op_sel_hi:[1,0]
    v_pk_fma_f32 v[130:131], v[128:129], v[18:19], v[28:29] op_sel:[1,1,0] op_sel_hi:[0,1,1] neg_lo:[0,1,0]
    v_cvt_pk_bf16_f32 v33, v128, v130
    v_cvt_pk_bf16_f32 v49, v129, v131
    v_pk_mul_f32 v[28:29], v[130:131], v[18:19] op_sel_hi:[1,0]
    v_pk_fma_f32 v[128:129], v[130:131], v[18:19], v[28:29] op_sel:[1,1,0] op_sel_hi:[0,1,1] neg_lo:[0,1,0]
    v_pk_mul_f32 v[28:29], v[128:129], v[18:19] op_sel_hi:[1,0]
    v_pk_fma_f32 v[130:131], v[128:129], v[18:19], v[28:29] op_sel:[1,1,0] op_sel_hi:[0,1,1] neg_lo:[0,1,0]
    v_cvt_pk_bf16_f32 v34, v128, v130
    v_cvt_pk_bf16_f32 v50, v129, v131
    v_pk_mul_f32 v[28:29], v[130:131], v[18:19] op_sel_hi:[1,0]
    v_pk_fma_f32 v[128:129], v[130:131], v[18:19], v[28:29] op_sel:[1,1,0] op_sel_hi:[0,1,1] neg_lo:[0,1,0]
    v_pk_mul_f32 v[28:29], v[128:129], v[18:19] op_sel_hi:[1,0]
    v_pk_fma_f32 v[130:131], v[128:129], v[18:19], v[28:29] op_sel:[1,1,0] op_sel_hi:[0,1,1] neg_lo:[0,1,0]
    v_cvt_pk_bf16_f32 v35, v128, v130
    v_cvt_pk_bf16_f32 v51, v129, v131
    v_pk_mul_f32 v[28:29], v[132:133], v[20:21] op_sel_hi:[1,0]
    v_pk_fma_f32 v[128:129], v[132:133], v[20:21], v[28:29] op_sel:[1,1,0] op_sel_hi:[0,1,1] neg_lo:[0,1,0]
    v_cvt_pk_bf16_f32 v36, v132, v128
    v_cvt_pk_bf16_f32 v52, v133, v129
    v_pk_mul_f32 v[28:29], v[128:129], v[20:21] op_sel_hi:[1,0]
    v_pk_fma_f32 v[130:131], v[128:129], v[20:21], v[28:29] op_sel:[1,1,0] op_sel_hi:[0,1,1] neg_lo:[0,1,0]
    v_cvt_pk_bf16_f32 v37, v130, v130
    v_cvt_pk_bf16_f32 v53, v131, v131
    v_pk_mul_f32 v[28:29], v[130:131], v[20:21] op_sel_hi:[1,0]
    v_pk_fma_f32 v[128:129], v[130:131], v[20:21], v[28:29] op_sel:[1,1,0] op_sel_hi:[0,1,1] neg_lo:[0,1,0]
    v_cvt_pk_bf16_f32 v38, v130, v128
    v_cvt_pk_bf16_f32 v54, v131, v129
    v_pk_mul_f32 v[28:29], v[128:129], v[20:21] op_sel_hi:[1,0]
    v_pk_fma_f32 v[130:131], v[128:129], v[20:21], v[28:29] op_sel:[1,1,0] op_sel_hi:[0,1,1] neg_lo:[0,1,0]
    v_cvt_pk_bf16_f32 v39, v130, v130
    v_cvt_pk_bf16_f32 v55, v131, v131
    v_pk_mul_f32 v[28:29], v[134:135], v[22:23] op_sel_hi:[1,0]
    v_pk_fma_f32 v[128:129], v[134:135], v[22:23], v[28:29] op_sel:[1,1,0] op_sel_hi:[0,1,1] neg_lo:[0,1,0]
    v_cvt_pk_bf16_f32 v40, v134, v128
    v_cvt_pk_bf16_f32 v56, v135, v129
    v_pk_mul_f32 v[28:29], v[128:129], v[22:23] op_sel_hi:[1,0]
    v_pk_fma_f32 v[130:131], v[128:129], v[22:23], v[28:29] op_sel:[1,1,0] op_sel_hi:[0,1,1] neg_lo:[0,1,0]
    v_cvt_pk_bf16_f32 v41, v130, v130
    v_cvt_pk_bf16_f32 v57, v131, v131
    v_pk_mul_f32 v[28:29], v[136:137], v[22:23] op_sel_hi:[1,0]
    v_pk_fma_f32 v[128:129], v[136:137], v[22:23], v[28:29] op_sel:[1,1,0] op_sel_hi:[0,1,1] neg_lo:[0,1,0]
    v_cvt_pk_bf16_f32 v42, v136, v128
    v_cvt_pk_bf16_f32 v58, v137, v129
    v_pk_mul_f32 v[28:29], v[128:129], v[22:23] op_sel_hi:[1,0]
    v_pk_fma_f32 v[130:131], v[128:129], v[22:23], v[28:29] op_sel:[1,1,0] op_sel_hi:[0,1,1] neg_lo:[0,1,0]
    v_cvt_pk_bf16_f32 v43, v130, v130
    v_cvt_pk_bf16_f32 v59, v131, v131
    v_pk_mul_f32 v[28:29], v[138:139], v[24:25] op_sel_hi:[1,0]
    v_pk_fma_f32 v[128:129], v[138:139], v[24:25], v[28:29] op_sel:[1,1,0] op_sel_hi:[0,1,1] neg_lo:[0,1,0]
    v_cvt_pk_bf16_f32 v44, v138, v128
    v_cvt_pk_bf16_f32 v60, v139, v129
    v_pk_mul_f32 v[28:29], v[142:143], v[24:25] op_sel_hi:[1,0]
    v_pk_fma_f32 v[128:129], v[142:143], v[24:25], v[28:29] op_sel:[1,1,0] op_sel_hi:[0,1,1] neg_lo:[0,1,0]
    v_cvt_pk_bf16_f32 v45, v142, v128
    v_cvt_pk_bf16_f32 v61, v143, v129
    v_pk_mul_f32 v[28:29], v[140:141], v[24:25] op_sel_hi:[1,0]
    v_pk_fma_f32 v[128:129], v[140:141], v[24:25], v[28:29] op_sel:[1,1,0] op_sel_hi:[0,1,1] neg_lo:[0,1,0]
    v_cvt_pk_bf16_f32 v46, v140, v128
    v_cvt_pk_bf16_f32 v62, v141, v129
    v_pk_mul_f32 v[28:29], v[144:145], v[24:25] op_sel_hi:[1,0]
    v_pk_fma_f32 v[128:129], v[144:145], v[24:25], v[28:29] op_sel:[1,1,0] op_sel_hi:[0,1,1] neg_lo:[0,1,0]
    v_cvt_pk_bf16_f32 v47, v144, v128
    v_cvt_pk_bf16_f32 v63, v145, v129
    ds_write_b128 v150, v[32:35]
    ds_write_b128 v151, v[36:39]
    ds_write_b128 v152, v[40:43]
    ds_write_b128 v153, v[44:47]
    ds_read_b64_tr_b16 v[96:97], v154 offset:0
    ds_read_b64_tr_b16 v[98:99], v155 offset:256
    ds_read_b64_tr_b16 v[100:101], v154 offset:1024
    ds_read_b64_tr_b16 v[102:103], v155 offset:1280
    ds_read_b64_tr_b16 v[104:105], v154 offset:2048
    ds_read_b64_tr_b16 v[106:107], v155 offset:2304
    ds_read_b64_tr_b16 v[108:109], v154 offset:3072
    ds_read_b64_tr_b16 v[110:111], v155 offset:3328
    s_waitcnt lgkmcnt(0)
    v_mfma_f32_32x32x16_bf16 v[112:127], v[96:99], v[64:67], 0
    v_mfma_f32_32x32x16_bf16 v[112:127], v[100:103], v[68:71], v[112:127]
    v_mfma_f32_32x32x16_bf16 v[112:127], v[104:107], v[72:75], v[112:127]
    v_mfma_f32_32x32x16_bf16 v[112:127], v[108:111], v[76:79], v[112:127]
    ds_write_b128 v150, v[48:51]
    ds_write_b128 v151, v[52:55]
    ds_write_b128 v152, v[56:59]
    ds_write_b128 v153, v[60:63]
    ds_read_b64_tr_b16 v[32:33], v154 offset:0
    ds_read_b64_tr_b16 v[34:35], v155 offset:256
    ds_read_b64_tr_b16 v[36:37], v154 offset:1024
    ds_read_b64_tr_b16 v[38:39], v155 offset:1280
    ds_read_b64_tr_b16 v[40:41], v154 offset:2048
    ds_read_b64_tr_b16 v[42:43], v155 offset:2304
    ds_read_b64_tr_b16 v[44:45], v154 offset:3072
    ds_read_b64_tr_b16 v[46:47], v155 offset:3328
    s_waitcnt lgkmcnt(0)
    v_mfma_f32_32x32x16_bf16 v[112:127], v[32:35], v[80:83], v[112:127]
    v_mfma_f32_32x32x16_bf16 v[112:127], v[36:39], v[84:87], v[112:127]
    v_mfma_f32_32x32x16_bf16 v[112:127], v[40:43], v[88:91], v[112:127]
    v_mfma_f32_32x32x16_bf16 v[112:127], v[44:47], v[92:95], v[112:127]
    s_setprio 3
Lw_29:
    ds_read_b32 v3, v1 offset:0
    s_waitcnt lgkmcnt(0)
    v_readfirstlane_b32 s8, v3
    s_nop 2
    s_cmp_ge_u32 s8, 4
    s_cbranch_scc1 Ld_30
    s_sleep 1
    s_sub_u32 s51, s51, 1
    s_cbranch_scc0 Lw_29
    s_mov_b32 s51, 0
Ld_30:
    ds_read_b32 v167, v1 offset:128
Lw_31:
    ds_read_b32 v3, v1 offset:24
    s_waitcnt lgkmcnt(0)
    v_readfirstlane_b32 s8, v3
    s_nop 2
    s_cmp_ge_u32 s8, 4
    s_cbranch_scc1 Ld_32
    s_sleep 2
    s_sub_u32 s51, s51, 1
    s_cbranch_scc0 Lw_31
    s_mov_b32 s51, 0
Ld_32:
    s_bitcmp0_b32 s6, 5
    s_cbranch_scc0 Ly_33
    s_lshr_b32 s12, s6, 5
    s_and_b32 s8, s6, 31
    s_lshl_b32 s8, s8, 1
    s_and_b32 s10, s7, 1
    s_add_u32 s8, s8, s10
    s_lshr_b32 s10, s7, 1
    s_xor_b32 s12, s12, s10
    s_mov_b32 s56, s26
    s_mov_b32 s57, s27
    s_mov_b32 s58, 2097152
    s_lshl_b32 s9, s8, 15
    s_lshl_b32 s10, s12, 7
    s_add_u32 s9, s9, s10
    v_and_b32 v29, 7, v0
    v_lshrrev_b32 v30, 3, v0
    v_lshlrev_b32 v28, 12, v30
    v_lshl_add_u32 v28, v29, 4, v28
    buffer_load_dwordx4 v[96:99], v28, s[56:59], s9 offen offset:0
    buffer_load_dwordx4 v[100:103], v28, s[56:59], s9 offen offset:1024
    buffer_load_dwordx4 v[104:107], v28, s[56:59], s9 offen offset:2048
    buffer_load_dwordx4 v[108:111], v28, s[56:59], s9 offen offset:3072
    s_lshl_b32 s47, s12, 18
    s_lshl_b32 s10, s8, 7
    s_add_u32 s47, s47, s10
    s_add_u32 s47, s47, 6291456
    v_lshlrev_b32 v28, 15, v29
    v_lshl_add_u32 v28, v30, 4, v28
Ly_33:
    v_mov_b32 v26, v156
    v_mov_b32 v27, v157
    s_lshl_b32 s10, s68, 12
    s_add_u32 s10, s10, 139264
    v_lshl_add_u32 v5, v0, 4, s10
    s_lshl_b32 s10, s68, 2
    v_add_u32 v6, s10, v1
    s_cmp_eq_u32 s69, 0
    s_cbranch_scc1 L_s_expand
    ds_write_b128 v5, v[112:115] offset:0
    ds_write_b128 v5, v[116:119] offset:1024
    ds_write_b128 v5, v[120:123] offset:2048
    ds_write_b128 v5, v[124:127] offset:3072
    s_waitcnt lgkmcnt(0)
    s_mov_b64 exec, 1
    ds_add_u32 v6, v2 offset:28
    s_mov_b64 exec, -1
    s_branch L_s_ucopy
L_s_expand:
Lw_34:
    ds_read_b32 v3, v6 offset:28
    s_waitcnt lgkmcnt(0)
    v_readfirstlane_b32 s8, v3
    s_nop 2
    s_cmp_ge_u32 s8, 1
    s_cbranch_scc1 Ld_35
    s_sleep 1
    s_sub_u32 s51, s51, 1
    s_cbranch_scc0 Lw_34
    s_mov_b32 s51, 0
Ld_35:
    ds_read_b128 v[32:35], v5 offset:0
    ds_read_b128 v[36:39], v5 offset:1024
    ds_read_b128 v[40:43], v5 offset:2048
    ds_read_b128 v[44:47], v5 offset:3072
    v_lshl_add_u32 v7, v0, 4, s46
    v_mov_b64 v[48:49], 0
    v_mov_b64 v[50:51], 0
    ds_write_b128 v7, v[48:51] offset:0
    ds_write_b128 v7, v[48:51] offset:1024
    ds_write_b128 v7, v[48:51] offset:1136
    ds_write_b128 v7, v[48:51] offset:6912
    ds_write_b128 v7, v[48:51] offset:7936
    ds_write_b128 v7, v[48:51] offset:8048
    s_waitcnt lgkmcnt(6)
    v_pk_add_f32 v[112:113], v[112:113], v[32:33]
    v_pk_add_f32 v[114:115], v[114:115], v[34:35]
    v_pk_add_f32 v[116:117], v[116:117], v[36:37]
    v_pk_add_f32 v[118:119], v[118:119], v[38:39]
    v_pk_add_f32 v[120:121], v[120:121], v[40:41]
    v_pk_add_f32 v[122:123], v[122:123], v[42:43]
    v_pk_add_f32 v[124:125], v[124:125], v[44:45]
    v_pk_add_f32 v[126:127], v[126:127], v[46:47]
    s_mov_b64 exec, 1
    v_add_f32 v112, s13, v112
    s_mov_b64 exec, -1
    s_mov_b32 s10, 0x55555555
    s_mov_b32 s11, 0x55555555
    v_cvt_pk_bf16_f32 v32, v115, v114
    v_cvt_pk_bf16_f32 v33, v113, v112
    ds_write_b64 v146, v[32:33] offset:2168
    v_cvt_pk_bf16_f32 v34, v118, v117
    v_cvt_pk_bf16_f32 v35, v116, v116
    ds_write_b64 v146, v[34:35] offset:2744
    v_cvt_pk_bf16_f32 v36, v122, v122
    v_cvt_pk_bf16_f32 v37, v121, v121
    v_cvt_pk_bf16_f32 v38, v121, v120
    v_cvt_pk_bf16_f32 v39, v120, v120
    ds_write_b128 v147, v[36:39] offset:3312
    v_cndmask_b32 v11, v125, v124, s[10:11]
    v_cvt_pk_bf16_f32 v40, v125, v125
    v_cvt_pk_bf16_f32 v41, v125, v11
    v_cvt_pk_bf16_f32 v42, v124, v124
    v_cvt_pk_bf16_f32 v43, v124, v124
    ds_write_b128 v147, v[40:43] offset:4464
    v_cndmask_b32 v11, v127, v126, s[10:11]
    v_cvt_pk_bf16_f32 v44, v127, v127
    v_cvt_pk_bf16_f32 v45, v127, v11
    v_cvt_pk_bf16_f32 v46, v126, v126
    v_cvt_pk_bf16_f32 v47, v126, v126
    ds_write_b128 v147, v[44:47] offset:5616
    ds_read_b128 v[64:67], v148 offset:2160
    ds_read_b32 v68, v149 offset:2160
    ds_read_b128 v[72:75], v148 offset:3312
    ds_read_b32 v76, v149 offset:3312
    ds_read_b128 v[80:83], v148 offset:4464
    ds_read_b32 v84, v149 offset:4464
    ds_read_b128 v[88:91], v148 offset:5616
    ds_read_b32 v92, v149 offset:5616
    s_waitcnt lgkmcnt(6)
    v_alignbit_b32 v32, v65, v64, 16
    v_alignbit_b32 v33, v66, v65, 16
    v_alignbit_b32 v34, v67, v66, 16
    v_alignbit_b32 v35, v68, v67, 16
    ds_write_b128 v148, v[32:35] offset:9072
    s_waitcnt lgkmcnt(5)
    v_alignbit_b32 v36, v73, v72, 16
    v_alignbit_b32 v37, v74, v73, 16
    v_alignbit_b32 v38, v75, v74, 16
    v_alignbit_b32 v39, v76, v75, 16
    ds_write_b128 v148, v[36:39] offset:10224
    s_waitcnt lgkmcnt(4)
    v_alignbit_b32 v40, v81, v80, 16
    v_alignbit_b32 v41, v82, v81, 16
    v_alignbit_b32 v42, v83, v82, 16
    v_alignbit_b32 v43, v84, v83, 16
    ds_write_b128 v148, v[40:43] offset:11376
    s_waitcnt lgkmcnt(3)
    v_alignbit_b32 v44, v89, v88, 16
    v_alignbit_b32 v45, v90, v89, 16
    v_alignbit_b32 v46, v91, v90, 16
    v_alignbit_b32 v47, v92, v91, 16
    ds_write_b128 v148, v[44:47] offset:12528
L_s_ucopy:
    s_bitcmp0_b32 s6, 5
    s_cbranch_scc0 Ly_36
    s_waitcnt vmcnt(0)
    v_swap_b32 v97, v100
    v_swap_b32 v98, v104
    v_swap_b32 v99, v108
    v_swap_b32 v102, v105
    v_swap_b32 v103, v109
    v_swap_b32 v107, v110
    buffer_store_dwordx4 v[96:99], v28, s[64:67], s47 offen sc1
    s_add_u32 s47, s47, 8192
    buffer_store_dwordx4 v[100:103], v28, s[64:67], s47 offen sc1
    s_add_u32 s47, s47, 8192
    buffer_store_dwordx4 v[104:107], v28, s[64:67], s47 offen sc1
    s_add_u32 s47, s47, 8192
    buffer_store_dwordx4 v[108:111], v28, s[64:67], s47 offen sc1
Ly_36:
    s_waitcnt lgkmcnt(0)
    s_bitcmp0_b32 s6, 5
    s_cbranch_scc0 Ly_37
    s_waitcnt vmcnt(0)
    s_mov_b64 exec, 1
    ds_add_rtn_u32 v3, v1, v2 offset:72
    s_mov_b64 exec, -1
    s_waitcnt lgkmcnt(0)
    v_readfirstlane_b32 s8, v3
    s_nop 2
    s_cmp_eq_u32 s8, 3
    s_cbranch_scc0 Lpub_38
    s_lshl_b32 s10, s6, 7
    s_add_u32 s10, s10, 69632
    v_mov_b32 v18, 0
    s_mov_b64 exec, 1
    buffer_store_dword v167, v18, s[64:67], s10 offen sc1
    s_mov_b64 exec, -1
Lpub_38:
Ly_37:
Lw_39:
    ds_read_b32 v3, v1 offset:20
    s_waitcnt lgkmcnt(0)
    v_readfirstlane_b32 s8, v3
    s_nop 2
    s_cmp_ge_u32 s8, 4
    s_cbranch_scc1 Ld_40
    s_sleep 2
    s_sub_u32 s51, s51, 1
    s_cbranch_scc0 Lw_39
    s_mov_b32 s51, 0
Ld_40:
    s_mov_b32 s56, s24
    s_mov_b32 s57, s25
    s_mov_b32 s58, 524288
    s_mov_b32 s59, 0x20000
    s_lshl_b32 s11, s7, 17
    s_lshl_b32 s10, s5, 7
    s_add_u32 s11, s11, s10
    s_lshl_b32 s12, s7, 13
    s_add_u32 s12, s12, 32768
    v_mov_b32 v16, v160
    v_xor_b32 v17, 64, v160
    s_mov_b32 m0, s12
    s_nop 0
    buffer_load_dwordx4 v161, s[56:59], s11 offen lds
    s_add_u32 m0, m0, 1024
    s_add_u32 s11, s11, 8192
    buffer_load_dwordx4 v161, s[56:59], s11 offen lds
    s_add_u32 m0, m0, 1024
    s_add_u32 s11, s11, 8192
    buffer_load_dwordx4 v161, s[56:59], s11 offen lds
    s_add_u32 m0, m0, 1024
    s_add_u32 s11, s11, 8192
    buffer_load_dwordx4 v161, s[56:59], s11 offen lds
    s_add_u32 m0, m0, 1024
    s_add_u32 s11, s11, 8192
    s_waitcnt vmcnt(0)
    buffer_load_dwordx4 v161, s[56:59], s11 offen lds
    s_add_u32 m0, m0, 1024
    s_add_u32 s11, s11, 8192
    buffer_load_dwordx4 v161, s[56:59], s11 offen lds
    s_add_u32 m0, m0, 1024
    s_add_u32 s11, s11, 8192
    buffer_load_dwordx4 v161, s[56:59], s11 offen lds
    s_add_u32 m0, m0, 1024
    s_add_u32 s11, s11, 8192
    buffer_load_dwordx4 v161, s[56:59], s11 offen lds
    s_add_u32 s11, s11, 8192
    s_waitcnt vmcnt(0)
    ds_read_b64_tr_b16 v[96:97], v16 offset:0
    ds_read_b64_tr_b16 v[98:99], v16 offset:512
    ds_read_b64_tr_b16 v[100:101], v17 offset:0
    ds_read_b64_tr_b16 v[102:103], v17 offset:512
    ds_read_b64_tr_b16 v[104:105], v16 offset:2048
    ds_read_b64_tr_b16 v[106:107], v16 offset:2560
    ds_read_b64_tr_b16 v[108:109], v17 offset:2048
    ds_read_b64_tr_b16 v[110:111], v17 offset:2560
    ds_read_b64_tr_b16 v[112:113], v16 offset:4096
    ds_read_b64_tr_b16 v[114:115], v16 offset:4608
    ds_read_b64_tr_b16 v[116:117], v17 offset:4096
    ds_read_b64_tr_b16 v[118:119], v17 offset:4608
    ds_read_b64_tr_b16 v[120:121], v16 offset:6144
    ds_read_b64_tr_b16 v[122:123], v16 offset:6656
    ds_read_b64_tr_b16 v[124:125], v17 offset:6144
    ds_read_b64_tr_b16 v[126:127], v17 offset:6656
    s_waitcnt lgkmcnt(0)
    s_mov_b32 m0, s12
    s_nop 0
    buffer_load_dwordx4 v161, s[56:59], s11 offen lds
    s_add_u32 m0, m0, 1024
    s_add_u32 s11, s11, 8192
    buffer_load_dwordx4 v161, s[56:59], s11 offen lds
    s_add_u32 m0, m0, 1024
    s_add_u32 s11, s11, 8192
    buffer_load_dwordx4 v161, s[56:59], s11 offen lds
    s_add_u32 m0, m0, 1024
    s_add_u32 s11, s11, 8192
    buffer_load_dwordx4 v161, s[56:59], s11 offen lds
    s_add_u32 m0, m0, 1024
    s_add_u32 s11, s11, 8192
    s_waitcnt vmcnt(0)
    buffer_load_dwordx4 v161, s[56:59], s11 offen lds
    s_add_u32 m0, m0, 1024
    s_add_u32 s11, s11, 8192
    buffer_load_dwordx4 v161, s[56:59], s11 offen lds
    s_add_u32 m0, m0, 1024
    s_add_u32 s11, s11, 8192
    buffer_load_dwordx4 v161, s[56:59], s11 offen lds
    s_add_u32 m0, m0, 1024
    s_add_u32 s11, s11, 8192
    buffer_load_dwordx4 v161, s[56:59], s11 offen lds
    s_add_u32 s11, s11, 8192
    s_waitcnt vmcnt(0)
    ds_read_b64_tr_b16 v[128:129], v16 offset:0
    ds_read_b64_tr_b16 v[130:131], v16 offset:512
    ds_read_b64_tr_b16 v[132:133], v17 offset:0
    ds_read_b64_tr_b16 v[134:135], v17 offset:512
    ds_read_b64_tr_b16 v[136:137], v16 offset:2048
    ds_read_b64_tr_b16 v[138:139], v16 offset:2560
    ds_read_b64_tr_b16 v[140:141], v17 offset:2048
    ds_read_b64_tr_b16 v[142:143], v17 offset:2560
    ds_read_b64_tr_b16 v[144:145], v16 offset:4096
    ds_read_b64_tr_b16 v[146:147], v16 offset:4608
    ds_read_b64_tr_b16 v[148:149], v17 offset:4096
    ds_read_b64_tr_b16 v[150:151], v17 offset:4608
    ds_read_b64_tr_b16 v[152:153], v16 offset:6144
    ds_read_b64_tr_b16 v[154:155], v16 offset:6656
    ds_read_b64_tr_b16 v[156:157], v17 offset:6144
    ds_read_b64_tr_b16 v[158:159], v17 offset:6656
    s_waitcnt lgkmcnt(0)
    s_lshr_b32 s12, s6, 6
    s_lshl_b32 s12, s12, 13
    s_add_u32 s12, s12, 69632
    v_lshlrev_b32 v18, 7, v0
    s_mov_b64 exec, 0xffffffff
Lpoll_41:
    buffer_load_dword v19, v18, s[64:67], s12 offen sc1
    s_waitcnt vmcnt(0)
    v_cmp_ne_u32 vcc, v167, v19
    s_nop 2
    s_and_b64 exec, exec, vcc
    s_cbranch_execz Lok_42
    s_sleep 4
    s_sub_u32 s51, s51, 1
    s_cbranch_scc0 Lpoll_41
    s_mov_b32 s51, 0
Lok_42:
    s_mov_b64 exec, -1
    s_lshl_b32 s9, s6, 13
    s_lshl_b32 s10, s7, 11
    s_add_u32 s9, s9, s10
    s_add_u32 s9, s9, 6291456
    v_lshlrev_b32 v4, 5, v0
    buffer_load_dwordx4 v[64:67], v4, s[64:67], s9 offen sc1
    buffer_load_dwordx4 v[68:71], v4, s[64:67], s9 offen offset:16 sc1
    s_cmp_eq_u32 s7, 0
    s_cbranch_scc0 L_s_nouz
    v_lshrrev_b32 v8, 3, v0
    v_mul_u32_u24 v8, 4416, v8
    v_and_b32 v9, 7, v0
    v_lshl_add_u32 v8, v9, 4, v8
    v_add_u32 v8, 65536, v8
    v_mov_b64 v[48:49], 0
    v_mov_b64 v[50:51], 0
    ds_write_b128 v8, v[48:51]
L_s_nouz:
    s_mov_b32 s8, 0x05040100
    s_mov_b32 s9, 0x07060302
    s_waitcnt vmcnt(0)
    v_perm_b32 v32, v65, v64, s8
    v_perm_b32 v36, v65, v64, s9
    v_perm_b32 v33, v67, v66, s8
    v_perm_b32 v37, v67, v66, s9
    v_perm_b32 v34, v69, v68, s8
    v_perm_b32 v38, v69, v68, s9
    v_perm_b32 v35, v71, v70, s8
    v_perm_b32 v39, v71, v70, s9
    v_add_u32 v9, 124, v166
    ds_write2_b32 v9, v32, v33 offset0:0 offset1:1
    ds_write2_b32 v9, v34, v35 offset0:2 offset1:3
    ds_write_b64 v166, v[32:33] offset:4536
    ds_write_b64 v166, v[34:35] offset:4544
    v_add_u32 v9, 8948, v166
    ds_write2_b32 v9, v32, v33 offset0:0 offset1:1
    ds_write2_b32 v9, v34, v35 offset0:2 offset1:3
    ds_write_b128 v166, v[32:35] offset:13360
    v_add_u32 v9, 17788, v166
    ds_write2_b32 v9, v36, v37 offset0:0 offset1:1
    ds_write2_b32 v9, v38, v39 offset0:2 offset1:3
    ds_write_b64 v166, v[36:37] offset:22200
    ds_write_b64 v166, v[38:39] offset:22208
    v_add_u32 v9, 26612, v166
    ds_write2_b32 v9, v36, v37 offset0:0 offset1:1
    ds_write2_b32 v9, v38, v39 offset0:2 offset1:3
    ds_write_b128 v166, v[36:39] offset:31024
    s_waitcnt lgkmcnt(0)
    s_mov_b64 exec, 1
    ds_add_u32 v1, v2 offset:36
    s_mov_b64 exec, -1
Lw_43:
    ds_read_b32 v3, v1 offset:36
    s_waitcnt lgkmcnt(0)
    v_readfirstlane_b32 s8, v3
    s_nop 2
    s_cmp_ge_u32 s8, 4
    s_cbranch_scc1 Ld_44
    s_sleep 1
    s_sub_u32 s51, s51, 1
    s_cbranch_scc0 Lw_43
    s_mov_b32 s51, 0
Ld_44:
    s_mov_b32 s12, 8
    ds_read_b128 v[32:35], v26 offset:2272
    ds_read_b128 v[40:43], v27 offset:0
    s_waitcnt lgkmcnt(0)
    v_mfma_f32_32x32x16_bf16 v[64:79], v[32:35], v[40:43], 0
    ds_read_b128 v[44:47], v27 offset:2048
    s_waitcnt lgkmcnt(0)
    v_mfma_f32_32x32x16_bf16 v[80:95], v[32:35], v[44:47], 0
    ds_read_b128 v[36:39], v26 offset:4576
    s_waitcnt lgkmcnt(0)
    v_mfma_f32_32x32x16_bf16 v[80:95], v[36:39], v[40:43], v[80:95]
    s_branch L_conv1
.p2align 6
L_conv_0:
    ds_read_b128 v[32:35], v26 offset:2272
    ds_read_b128 v[40:43], v27 offset:0
    s_waitcnt lgkmcnt(0)
    v_mfma_f32_32x32x16_bf16 v[64:79], v[32:35], v[40:43], v[64:79]
    ds_read_b128 v[44:47], v27 offset:2048
    s_waitcnt lgkmcnt(0)
    v_mfma_f32_32x32x16_bf16 v[80:95], v[32:35], v[44:47], v[80:95]
    ds_read_b128 v[36:39], v26 offset:4576
    s_waitcnt lgkmcnt(0)
    v_mfma_f32_32x32x16_bf16 v[80:95], v[36:39], v[40:43], v[80:95]
L_conv1:
    ds_read_b128 v[48:51], v26 offset:2240
    ds_read_b128 v[56:59], v27 offset:32
    s_waitcnt lgkmcnt(0)
    v_mfma_f32_32x32x16_bf16 v[64:79], v[48:51], v[56:59], v[64:79]
    ds_read_b128 v[60:63], v27 offset:2080
    s_waitcnt lgkmcnt(0)
    v_mfma_f32_32x32x16_bf16 v[80:95], v[48:51], v[60:63], v[80:95]
    ds_read_b128 v[52:55], v26 offset:4544
    s_waitcnt lgkmcnt(0)
    v_mfma_f32_32x32x16_bf16 v[80:95], v[52:55], v[56:59], v[80:95]
    ds_read_b128 v[32:35], v26 offset:2208
    ds_read_b128 v[40:43], v27 offset:64
    s_waitcnt lgkmcnt(0)
    v_mfma_f32_32x32x16_bf16 v[64:79], v[32:35], v[40:43], v[64:79]
    ds_read_b128 v[44:47], v27 offset:2112
    s_waitcnt lgkmcnt(0)
    v_mfma_f32_32x32x16_bf16 v[80:95], v[32:35], v[44:47], v[80:95]
    ds_read_b128 v[36:39], v26 offset:4512
    s_waitcnt lgkmcnt(0)
    v_mfma_f32_32x32x16_bf16 v[80:95], v[36:39], v[40:43], v[80:95]
    ds_read_b128 v[48:51], v26 offset:2176
    ds_read_b128 v[56:59], v27 offset:96
    s_waitcnt lgkmcnt(0)
    v_mfma_f32_32x32x16_bf16 v[64:79], v[48:51], v[56:59], v[64:79]
    ds_read_b128 v[60:63], v27 offset:2144
    s_waitcnt lgkmcnt(0)
    v_mfma_f32_32x32x16_bf16 v[80:95], v[48:51], v[60:63], v[80:95]
    ds_read_b128 v[52:55], v26 offset:4480
    s_waitcnt lgkmcnt(0)
    v_mfma_f32_32x32x16_bf16 v[80:95], v[52:55], v[56:59], v[80:95]
    v_subrev_u32 v26, 144, v26
    v_add_u32 v27, 128, v27
    s_sub_u32 s12, s12, 1
    s_cmp_lg_u32 s12, 0
    s_cbranch_scc1 L_conv_0
    s_waitcnt lgkmcnt(0)
    s_lshl_b32 s10, s7, 11
    s_add_u32 s10, s10, 103424
    v_lshl_add_u32 v10, v0, 4, s10
    s_lshl_b32 s10, s7, 13
    s_add_u32 s10, s10, 103424
    v_lshl_add_u32 v11, v0, 4, s10
    ds_write_b128 v10, v[64:67] offset:0
    ds_write_b128 v10, v[72:75] offset:1024
    ds_write_b128 v10, v[68:71] offset:8192
    ds_write_b128 v10, v[76:79] offset:9216
    ds_write_b128 v10, v[80:83] offset:16384
    ds_write_b128 v10, v[88:91] offset:17408
    ds_write_b128 v10, v[84:87] offset:24576
    ds_write_b128 v10, v[92:95] offset:25600
    s_waitcnt lgkmcnt(0)
    s_mov_b64 exec, 1
    ds_add_u32 v1, v2 offset:40
    s_mov_b64 exec, -1
    s_mov_b32 s60, s44
    s_mov_b32 s61, s45
    s_mov_b32 s62, 4194304
    s_mov_b32 s63, 0x20000
    s_lshl_b32 s9, s6, 13
    s_lshl_b32 s10, s7, 11
    s_add_u32 s9, s9, s10
    s_add_u32 s9, s9, 8388608
Lw_45:
    ds_read_b32 v3, v1 offset:40
    s_waitcnt lgkmcnt(0)
    v_readfirstlane_b32 s8, v3
    s_nop 2
    s_cmp_ge_u32 s8, 4
    s_cbranch_scc1 Ld_46
    s_sleep 1
    s_sub_u32 s51, s51, 1
    s_cbranch_scc0 Lw_45
    s_mov_b32 s51, 0
Ld_46:
    ds_read_b128 v[32:35], v11 offset:0
    ds_read_b128 v[36:39], v11 offset:1024
    ds_read_b128 v[40:43], v11 offset:2048
    ds_read_b128 v[44:47], v11 offset:3072
    ds_read_b128 v[48:51], v11 offset:4096
    ds_read_b128 v[52:55], v11 offset:5120
    ds_read_b128 v[56:59], v11 offset:6144
    ds_read_b128 v[60:63], v11 offset:7168
    s_waitcnt lgkmcnt(0)
    v_pk_add_f32 v[32:33], v[32:33], v[48:49]
    v_pk_add_f32 v[34:35], v[34:35], v[50:51]
    v_pk_add_f32 v[36:37], v[36:37], v[52:53]
    v_pk_add_f32 v[38:39], v[38:39], v[54:55]
    v_pk_add_f32 v[40:41], v[40:41], v[56:57]
    v_pk_add_f32 v[42:43], v[42:43], v[58:59]
    v_pk_add_f32 v[44:45], v[44:45], v[60:61]
    v_pk_add_f32 v[46:47], v[46:47], v[62:63]
    v_cvt_pk_bf16_f32 v48, v36, v44
    v_cvt_pk_bf16_f32 v49, v32, v40
    v_cvt_pk_bf16_f32 v50, v37, v45
    v_cvt_pk_bf16_f32 v51, v33, v41
    v_cvt_pk_bf16_f32 v52, v38, v46
    v_cvt_pk_bf16_f32 v53, v34, v42
    v_cvt_pk_bf16_f32 v54, v39, v47
    v_cvt_pk_bf16_f32 v55, v35, v43
    buffer_store_dwordx2 v[48:49], v162, s[64:67], s9 offen offset:0 sc1
    buffer_store_dwordx2 v[50:51], v162, s[64:67], s9 offen offset:256 sc1
    buffer_store_dwordx2 v[52:53], v162, s[64:67], s9 offen offset:512 sc1
    buffer_store_dwordx2 v[54:55], v162, s[64:67], s9 offen offset:768 sc1
    s_lshl_b32 s9, s4, 6
    s_lshl_b32 s10, s5, 2
    s_add_u32 s9, s9, s10
    s_add_u32 s9, s9, s7
    s_lshl_b32 s9, s9, 10
    s_add_u32 s9, s9, 524288
    s_add_u32 s10, s9, 32768
    v_mov_b64 v[20:21], -1
    v_mov_b64 v[22:23], -1
    v_lshlrev_b32 v14, 4, v0
    buffer_store_dwordx4 v[20:23], v14, s[64:67], s9 offen sc1
    buffer_store_dwordx4 v[20:23], v14, s[64:67], s10 offen sc1
    s_waitcnt vmcnt(0)
    s_mov_b64 exec, 1
    ds_add_rtn_u32 v3, v1, v2 offset:76
    s_mov_b64 exec, -1
    s_waitcnt lgkmcnt(0)
    v_readfirstlane_b32 s8, v3
    s_nop 2
    s_cmp_eq_u32 s8, 3
    s_cbranch_scc0 Lpub_47
    s_lshl_b32 s10, s6, 7
    s_add_u32 s10, s10, 102400
    v_mov_b32 v18, 0
    s_mov_b64 exec, 1
    buffer_store_dword v167, v18, s[64:67], s10 offen sc1
    s_mov_b64 exec, -1
Lpub_47:
    s_lshr_b32 s12, s6, 5
    s_lshl_b32 s10, s12, 12
    s_add_u32 s10, s10, 102400
    v_lshlrev_b32 v18, 7, v0
    s_mov_b64 exec, 0xffffffff
Lpoll_48:
    buffer_load_dword v19, v18, s[64:67], s10 offen sc1
    s_waitcnt vmcnt(0)
    v_cmp_ne_u32 vcc, v167, v19
    s_nop 2
    s_and_b64 exec, exec, vcc
    s_cbranch_execz Lok_49
    s_sleep 8
    s_sub_u32 s51, s51, 1
    s_cbranch_scc0 Lpoll_48
    s_mov_b32 s51, 0
Lok_49:
    s_mov_b64 exec, -1
    s_cmp_ge_u32 s7, 2
    s_cbranch_scc0 Ly_50
    s_mov_b32 s60, s44
    s_mov_b32 s61, s45
    s_mov_b32 s62, 4194304
    s_mov_b32 s63, 0x20000
    s_lshr_b32 s12, s6, 5
    s_and_b32 s8, s6, 31
    s_lshl_b32 s8, s8, 1
    s_and_b32 s10, s7, 1
    s_add_u32 s8, s8, s10
    s_lshl_b32 s9, s12, 18
    s_lshl_b32 s10, s8, 7
    s_add_u32 s9, s9, s10
    s_add_u32 s9, s9, 8388608
    v_and_b32 v5, 7, v0
    v_lshrrev_b32 v6, 3, v0
    v_lshlrev_b32 v4, 15, v6
    v_lshl_add_u32 v4, v5, 4, v4
    buffer_load_dwordx4 v[32:35], v4, s[64:67], s9 offen sc1
    s_add_u32 s9, s9, 8192
    buffer_load_dwordx4 v[36:39], v4, s[64:67], s9 offen sc1
    s_add_u32 s9, s9, 8192
    buffer_load_dwordx4 v[40:43], v4, s[64:67], s9 offen sc1
    s_add_u32 s9, s9, 8192
    buffer_load_dwordx4 v[44:47], v4, s[64:67], s9 offen sc1
    s_lshl_b32 s9, s8, 16
    s_lshl_b32 s10, s12, 7
    s_add_u32 s9, s9, s10
    s_add_u32 s9, s9, 1024
    s_add_u32 s10, s9, 4096
    v_lshlrev_b32 v4, 13, v5
    v_lshl_add_u32 v4, v6, 4, v4
    s_waitcnt vmcnt(0)
    v_swap_b32 v33, v36
    v_swap_b32 v34, v40
    v_swap_b32 v35, v44
    v_swap_b32 v38, v41
    v_swap_b32 v39, v45
    v_swap_b32 v43, v46
    buffer_store_dwordx4 v[32:35], v4, s[60:63], s9 offen offset:0 sc1
    buffer_store_dwordx4 v[36:39], v4, s[60:63], s9 offen offset:2048 sc1
    buffer_store_dwordx4 v[40:43], v4, s[60:63], s10 offen offset:0 sc1
    buffer_store_dwordx4 v[44:47], v4, s[60:63], s10 offen offset:2048 sc1
    s_nop 1
Ly_50:
    s_lshl_b32 s11, s4, 16
    s_lshl_b32 s10, s7, 13
    s_add_u32 s11, s11, s10
    s_add_u32 s11, s11, 524288
    s_lshl_b32 s9, s4, 17
    s_lshl_b32 s10, s5, 7
    s_add_u32 s9, s9, s10
    s_lshl_b32 s10, s7, 14
    s_add_u32 s9, s9, s10
    v_mov_b32 v12, v165
    v_mov_b32 v10, v163
    v_mov_b32 v11, v164
    s_add_u32 s12, s11, 4096
Lw_51:
    ds_read_b32 v3, v1 offset:64
    s_waitcnt lgkmcnt(0)
    v_readfirstlane_b32 s8, v3
    s_nop 2
    s_cmp_ge_u32 s8, 4
    s_cbranch_scc1 Ld_52
    s_sleep 1
    s_sub_u32 s51, s51, 1
    s_cbranch_scc0 Lw_51
    s_mov_b32 s51, 0
Ld_52:
    v_lshlrev_b32 v18, 10, v0
    s_mov_b64 exec, 0xff
L_lpoll:
    buffer_load_dword v19, v18, s[64:67], s11 offen offset:1020 sc1
    s_waitcnt vmcnt(0)
    v_cmp_eq_u32 vcc, -1, v19
    s_nop 2
    s_and_b64 exec, exec, vcc
    s_cbranch_execz L_lok
    s_sub_u32 s51, s51, 1
    s_cbranch_scc0 L_lpoll
    s_mov_b32 s51, 0
L_lok:
    s_mov_b64 exec, -1
L_o0:
    buffer_load_dwordx4 v[32:35], v14, s[64:67], s11 offen offset:0 sc1
    buffer_load_dwordx4 v[36:39], v14, s[64:67], s11 offen offset:1024 sc1
    buffer_load_dwordx4 v[40:43], v14, s[64:67], s11 offen offset:2048 sc1
    buffer_load_dwordx4 v[44:47], v14, s[64:67], s11 offen offset:3072 sc1
    buffer_load_dwordx4 v[48:51], v14, s[64:67], s12 offen offset:0 sc1
    buffer_load_dwordx4 v[52:55], v14, s[64:67], s12 offen offset:1024 sc1
    buffer_load_dwordx4 v[56:59], v14, s[64:67], s12 offen offset:2048 sc1
    buffer_load_dwordx4 v[60:63], v14, s[64:67], s12 offen offset:3072 sc1
    s_waitcnt vmcnt(7)
    v_max_u32 v15, v32, v33
    v_mfma_f32_32x32x16_bf16 v[64:79], v[96:99], v[32:35], 0
    v_mfma_f32_32x32x16_bf16 v[80:95], v[100:103], v[32:35], 0
    v_max3_u32 v15, v15, v34, v35
    s_waitcnt vmcnt(6)
    v_max3_u32 v15, v15, v36, v37
    v_mfma_f32_32x32x16_bf16 v[64:79], v[104:107], v[36:39], v[64:79]
    v_mfma_f32_32x32x16_bf16 v[80:95], v[108:111], v[36:39], v[80:95]
    v_max3_u32 v15, v15, v38, v39
    s_waitcnt vmcnt(5)
    v_max3_u32 v15, v15, v40, v41
    v_mfma_f32_32x32x16_bf16 v[64:79], v[112:115], v[40:43], v[64:79]
    v_mfma_f32_32x32x16_bf16 v[80:95], v[116:119], v[40:43], v[80:95]
    v_max3_u32 v15, v15, v42, v43
    s_waitcnt vmcnt(4)
    v_max3_u32 v15, v15, v44, v45
    v_mfma_f32_32x32x16_bf16 v[64:79], v[120:123], v[44:47], v[64:79]
    v_mfma_f32_32x32x16_bf16 v[80:95], v[124:127], v[44:47], v[80:95]
    v_max3_u32 v15, v15, v46, v47
    s_waitcnt vmcnt(3)
    v_max3_u32 v15, v15, v48, v49
    v_mfma_f32_32x32x16_bf16 v[64:79], v[128:131], v[48:51], v[64:79]
    v_mfma_f32_32x32x16_bf16 v[80:95], v[132:135], v[48:51], v[80:95]
    v_max3_u32 v15, v15, v50, v51
    s_waitcnt vmcnt(2)
    v_max3_u32 v15, v15, v52, v53
    v_mfma_f32_32x32x16_bf16 v[64:79], v[136:139], v[52:55], v[64:79]
    v_mfma_f32_32x32x16_bf16 v[80:95], v[140:143], v[52:55], v[80:95]
    v_max3_u32 v15, v15, v54, v55
    s_waitcnt vmcnt(1)
    v_max3_u32 v15, v15, v56, v57
    v_mfma_f32_32x32x16_bf16 v[64:79], v[144:147], v[56:59], v[64:79]
    v_mfma_f32_32x32x16_bf16 v[80:95], v[148:151], v[56:59], v[80:95]
    v_max3_u32 v15, v15, v58, v59
    s_waitcnt vmcnt(0)
    v_max3_u32 v15, v15, v60, v61
    v_mfma_f32_32x32x16_bf16 v[64:79], v[152:155], v[60:63], v[64:79]
    v_mfma_f32_32x32x16_bf16 v[80:95], v[156:159], v[60:63], v[80:95]
    v_max3_u32 v15, v15, v62, v63
    v_cmp_ne_u32 vcc, -1, v15
    s_nop 2
    s_cmp_eq_u64 vcc, exec
    s_cbranch_scc1 L_o0ok
    s_sub_u32 s51, s51, 1
    s_cbranch_scc0 L_o0
    s_mov_b32 s51, 0
L_o0ok:
    s_add_u32 s11, s11, 32768
    s_add_u32 s12, s12, 32768
    s_and_b32 s10, s7, 1
    s_mul_i32 s10, s10, 37888
    v_add_u32 v9, s10, v10
    s_sub_u32 s10, 37888, s10
    v_add_u32 v8, s10, v10
    v_mov_b32 v10, v9
    s_nop 3
    ds_write_b128 v10, v[64:67] offset:0
    ds_write_b128 v10, v[68:71] offset:1152
    ds_write_b128 v10, v[72:75] offset:9344
    ds_write_b128 v10, v[76:79] offset:10496
    ds_write_b128 v10, v[80:83] offset:18688
    ds_write_b128 v10, v[84:87] offset:19840
    ds_write_b128 v10, v[88:91] offset:28032
    ds_write_b128 v10, v[92:95] offset:29184
    v_mov_b32 v10, v8
L_o1:
Lw_53:
    ds_read_b32 v3, v1 offset:68
    s_waitcnt lgkmcnt(0)
    v_readfirstlane_b32 s8, v3
    s_nop 2
    s_cmp_ge_u32 s8, 4
    s_cbranch_scc1 Ld_54
    s_sub_u32 s51, s51, 1
    s_cbranch_scc0 Lw_53
    s_mov_b32 s51, 0
Ld_54:
    buffer_load_dwordx4 v[32:35], v14, s[64:67], s11 offen offset:0 sc1
    buffer_load_dwordx4 v[36:39], v14, s[64:67], s11 offen offset:1024 sc1
    buffer_load_dwordx4 v[40:43], v14, s[64:67], s11 offen offset:2048 sc1
    buffer_load_dwordx4 v[44:47], v14, s[64:67], s11 offen offset:3072 sc1
    buffer_load_dwordx4 v[48:51], v14, s[64:67], s12 offen offset:0 sc1
    buffer_load_dwordx4 v[52:55], v14, s[64:67], s12 offen offset:1024 sc1
    buffer_load_dwordx4 v[56:59], v14, s[64:67], s12 offen offset:2048 sc1
    buffer_load_dwordx4 v[60:63], v14, s[64:67], s12 offen offset:3072 sc1
    s_waitcnt vmcnt(7)
    v_max_u32 v15, v32, v33
    v_mfma_f32_32x32x16_bf16 v[64:79], v[96:99], v[32:35], 0
    v_mfma_f32_32x32x16_bf16 v[80:95], v[100:103], v[32:35], 0
    v_max3_u32 v15, v15, v34, v35
    s_waitcnt vmcnt(6)
    v_max3_u32 v15, v15, v36, v37
    v_mfma_f32_32x32x16_bf16 v[64:79], v[104:107], v[36:39], v[64:79]
    v_mfma_f32_32x32x16_bf16 v[80:95], v[108:111], v[36:39], v[80:95]
    v_max3_u32 v15, v15, v38, v39
    s_waitcnt vmcnt(5)
    v_max3_u32 v15, v15, v40, v41
    v_mfma_f32_32x32x16_bf16 v[64:79], v[112:115], v[40:43], v[64:79]
    v_mfma_f32_32x32x16_bf16 v[80:95], v[116:119], v[40:43], v[80:95]
    v_max3_u32 v15, v15, v42, v43
    s_waitcnt vmcnt(4)
    v_max3_u32 v15, v15, v44, v45
    v_mfma_f32_32x32x16_bf16 v[64:79], v[120:123], v[44:47], v[64:79]
    v_mfma_f32_32x32x16_bf16 v[80:95], v[124:127], v[44:47], v[80:95]
    v_max3_u32 v15, v15, v46, v47
    s_waitcnt vmcnt(3)
    v_max3_u32 v15, v15, v48, v49
    v_mfma_f32_32x32x16_bf16 v[64:79], v[128:131], v[48:51], v[64:79]
    v_mfma_f32_32x32x16_bf16 v[80:95], v[132:135], v[48:51], v[80:95]
    v_max3_u32 v15, v15, v50, v51
    s_waitcnt vmcnt(2)
    v_max3_u32 v15, v15, v52, v53
    v_mfma_f32_32x32x16_bf16 v[64:79], v[136:139], v[52:55], v[64:79]
    v_mfma_f32_32x32x16_bf16 v[80:95], v[140:143], v[52:55], v[80:95]
    v_max3_u32 v15, v15, v54, v55
    s_waitcnt vmcnt(1)
    v_max3_u32 v15, v15, v56, v57
    v_mfma_f32_32x32x16_bf16 v[64:79], v[144:147], v[56:59], v[64:79]
    v_mfma_f32_32x32x16_bf16 v[80:95], v[148:151], v[56:59], v[80:95]
    v_max3_u32 v15, v15, v58, v59
    s_waitcnt vmcnt(0)
    v_max3_u32 v15, v15, v60, v61
    v_mfma_f32_32x32x16_bf16 v[64:79], v[152:155], v[60:63], v[64:79]
    v_mfma_f32_32x32x16_bf16 v[80:95], v[156:159], v[60:63], v[80:95]
    v_max3_u32 v15, v15, v62, v63
    v_cmp_ne_u32 vcc, -1, v15
    s_nop 2
    s_cmp_eq_u64 vcc, exec
    s_cbranch_scc1 L_o1ok
    s_sub_u32 s51, s51, 1
    s_cbranch_scc0 L_o1
    s_mov_b32 s51, 0
L_o1ok:
    v_add_u32 v9, 37888, v11
    s_add_u32 s10, s9, 65536
    s_nop 3
    ds_write_b128 v10, v[64:67] offset:0
    ds_write_b128 v10, v[68:71] offset:1152
    ds_write_b128 v10, v[72:75] offset:9344
    ds_write_b128 v10, v[76:79] offset:10496
    ds_write_b128 v10, v[80:83] offset:18688
    ds_write_b128 v10, v[84:87] offset:19840
    ds_write_b128 v10, v[88:91] offset:28032
    ds_write_b128 v10, v[92:95] offset:29184
    s_waitcnt lgkmcnt(0)
    s_barrier
    ds_read_b128 v[64:67], v11 offset:0
    ds_read_b128 v[68:71], v11 offset:1152
    ds_read_b128 v[72:75], v11 offset:2304
    ds_read_b128 v[76:79], v11 offset:3456
    ds_read_b128 v[80:83], v11 offset:4608
    ds_read_b128 v[84:87], v11 offset:5760
    ds_read_b128 v[88:91], v11 offset:6912
    ds_read_b128 v[92:95], v11 offset:8064
    s_waitcnt lgkmcnt(4)
    v_pk_add_f32 v[64:65], v[64:65], v[72:73]
    v_pk_add_f32 v[66:67], v[66:67], v[74:75]
    v_pk_add_f32 v[68:69], v[68:69], v[76:77]
    v_pk_add_f32 v[70:71], v[70:71], v[78:79]
    ds_read_b128 v[32:35], v9 offset:0
    ds_read_b128 v[36:39], v9 offset:1152
    ds_read_b128 v[40:43], v9 offset:2304
    ds_read_b128 v[44:47], v9 offset:3456
    ds_read_b128 v[48:51], v9 offset:4608
    ds_read_b128 v[52:55], v9 offset:5760
    ds_read_b128 v[56:59], v9 offset:6912
    ds_read_b128 v[60:63], v9 offset:8064
    s_waitcnt lgkmcnt(10)
    v_pk_add_f32 v[64:65], v[64:65], v[80:81]
    v_pk_add_f32 v[66:67], v[66:67], v[82:83]
    v_pk_add_f32 v[68:69], v[68:69], v[84:85]
    v_pk_add_f32 v[70:71], v[70:71], v[86:87]
    s_waitcnt lgkmcnt(8)
    v_pk_add_f32 v[64:65], v[64:65], v[88:89]
    v_pk_add_f32 v[66:67], v[66:67], v[90:91]
    v_pk_add_f32 v[68:69], v[68:69], v[92:93]
    v_pk_add_f32 v[70:71], v[70:71], v[94:95]
    v_cvt_pk_bf16_f32 v20, v64, v65
    v_cvt_pk_bf16_f32 v21, v66, v67
    v_cvt_pk_bf16_f32 v22, v68, v69
    v_cvt_pk_bf16_f32 v23, v70, v71
    buffer_store_dwordx4 v[20:23], v12, s[60:63], s9 offen
    s_waitcnt lgkmcnt(4)
    v_pk_add_f32 v[32:33], v[32:33], v[40:41]
    v_pk_add_f32 v[34:35], v[34:35], v[42:43]
    v_pk_add_f32 v[36:37], v[36:37], v[44:45]
    v_pk_add_f32 v[38:39], v[38:39], v[46:47]
    s_waitcnt lgkmcnt(2)
    v_pk_add_f32 v[32:33], v[32:33], v[48:49]
    v_pk_add_f32 v[34:35], v[34:35], v[50:51]
    v_pk_add_f32 v[36:37], v[36:37], v[52:53]
    v_pk_add_f32 v[38:39], v[38:39], v[54:55]
    s_waitcnt lgkmcnt(0)
    v_pk_add_f32 v[32:33], v[32:33], v[56:57]
    v_pk_add_f32 v[34:35], v[34:35], v[58:59]
    v_pk_add_f32 v[36:37], v[36:37], v[60:61]
    v_pk_add_f32 v[38:39], v[38:39], v[62:63]
    v_cvt_pk_bf16_f32 v24, v32, v33
    v_cvt_pk_bf16_f32 v25, v34, v35
    v_cvt_pk_bf16_f32 v26, v36, v37
    v_cvt_pk_bf16_f32 v27, v38, v39
    buffer_store_dwordx4 v[24:27], v12, s[60:63], s10 offen
    s_branch L_end
L_end:
L_exit:
    s_endpgm
.section .rodata,"a"
.p2align 6
.amdhsa_kernel concat_heads__grouped_kv_mqa__ssm_conv_s4__prompt_kernel
  .amdhsa_next_free_vgpr 168
  .amdhsa_next_free_sgpr 98
  .amdhsa_accum_offset 168
  .amdhsa_group_segment_fixed_size 0
  .amdhsa_kernarg_size 136
  .amdhsa_user_sgpr_count 2
  .amdhsa_user_sgpr_kernarg_segment_ptr 1
  .amdhsa_system_sgpr_workgroup_id_x 1
  .amdhsa_float_denorm_mode_32 3
.end_amdhsa_kernel
```
